```python
import torch

def _softmax(x, axis=-1):
    return torch.softmax(x, dim=axis)
def _gelu(x):
    return torch.nn.functional.gelu(x, approximate="tanh")
def _silu(x):
    return torch.nn.functional.silu(x)
def _sigmoid(x):
    return torch.sigmoid(x)
def _layernorm(x, axis=-1, eps=1e-5):
    m = x.mean(dim=axis, keepdim=True)
    v = x.var(dim=axis, keepdim=True, unbiased=False)
    return (x - m) / torch.sqrt(v + eps)
def _scatter_add(tgt, idx, src, axis=0):
    return tgt.clone().index_add_(axis, idx, src)
def _segment_sum(src, seg, n):
    out = torch.zeros((n,) + src.shape[1:], dtype=src.dtype)
    return out.index_add_(0, seg, src)
def _pad(x, pw):
    flat = tuple(v for pair in reversed(pw) for v in pair)
    return torch.nn.functional.pad(x, flat)

kernel_name = 'concat_heads__sliding_block_cached__mha_block_cached__decode'

def setup_inputs():

    _w = (lambda a: (lambda t: t.to(torch.bfloat16) if t.is_floating_point() else t)(torch.as_tensor(a)))
    def _A_setup():
        B, Sq, D = 1, 1, 448
        Hq, Hkv, Sk, Dh = 16, 8, 8192, 256
        assert Hq % Hkv == 0, (Hq, Hkv)
        return {
            "x": _w((lambda *s: torch.randn(*s, dtype=torch.bfloat16) * 0.8)(B, Sq, D)),
            "k_cache": _w((lambda *s: torch.randn(*s, dtype=torch.bfloat16) * 1.6)(B, Hkv, Sk, Dh)),
            "v_cache": _w((lambda *s: torch.randn(*s, dtype=torch.bfloat16) * 0.2)(B, Hkv, Sk, Dh)),
            "wq": _w((lambda *s: torch.randn(*s, dtype=torch.bfloat16) * 1.6)(D, Hq * Dh) * (D ** -0.5)),
            "wo": _w((lambda *s: torch.randn(*s, dtype=torch.bfloat16) * 0.2)(Hq * Dh, D) * ((Hq * Dh) ** -0.5)),
        }
    _A_in = _A_setup()

    def _B_setup():
        B, Sq, D = 1, 1, 448
        H, Sk, Dh = 16, 8192, 256
        return {
            "x": _w((lambda *s: torch.randn(*s, dtype=torch.bfloat16) * 0.8)(B, Sq, D)),
            "k_cache": _w((lambda *s: torch.randn(*s, dtype=torch.bfloat16) * 1.6)(B, H, Sk, Dh)),
            "v_cache": _w((lambda *s: torch.randn(*s, dtype=torch.bfloat16) * 0.2)(B, H, Sk, Dh)),
            "wq": _w((lambda *s: torch.randn(*s, dtype=torch.bfloat16) * 1.6)(D, H * Dh) * (D ** -0.5)),
            "wo": _w((lambda *s: torch.randn(*s, dtype=torch.bfloat16) * 0.2)(H * Dh, D) * ((H * Dh) ** -0.5)),
        }
    _B_in = _B_setup()

    return {
        "A_x": _A_in["x"],
        "A_k_cache": _A_in["k_cache"],
        "A_v_cache": _A_in["v_cache"],
        "A_wq": _A_in["wq"],
        "A_wo": _A_in["wo"],
        "B_x": _B_in["x"],
        "B_k_cache": _B_in["k_cache"],
        "B_v_cache": _B_in["v_cache"],
        "B_wq": _B_in["wq"],
        "B_wo": _B_in["wo"],
    }

def reference(A_x, A_k_cache, A_v_cache, A_wq, A_wo, B_x, B_k_cache, B_v_cache, B_wq, B_wo):
    def _A_ref(x, k_cache, v_cache, wq, wo):
        B, Sq, D = x.shape
        Hq, Dh = 16, 256
        Hkv, Sk = k_cache.shape[1], k_cache.shape[2]
        W = min(4096, max(256, Sk // 4))
        rep = Hq // Hkv
        q = (lambda x, *d: x.permute(*d))((x @ wq).reshape(B, Sq, Hq, Dh), 0, 2, 1, 3)
        k = (lambda x, n, axis: torch.repeat_interleave(x, n, dim=axis))(k_cache[:, :, Sk - W:, :], rep, axis=1)
        v = (lambda x, n, axis: torch.repeat_interleave(x, n, dim=axis))(v_cache[:, :, Sk - W:, :], rep, axis=1)
        scores = torch.einsum("bhqd,bhkd->bhqk", q, k) * (Dh ** -0.5)
        p = _softmax(scores, axis=-1)
        o = torch.einsum("bhqk,bhkd->bhqd", p, v)
        return (lambda x, *d: x.permute(*d))(o, 0, 2, 1, 3).reshape(B, Sq, Hq * Dh) @ wo

    def _B_ref(x, k_cache, v_cache, wq, wo):
        B, Sq, D = x.shape
        H, Dh = 16, 256
        q = (lambda x, *d: x.permute(*d))((x @ wq).reshape(B, Sq, H, Dh), 0, 2, 1, 3)
        scores = torch.einsum("bhqd,bhkd->bhqk", q, k_cache) * (Dh ** -0.5)
        p = _softmax(scores, axis=-1)
        o = torch.einsum("bhqk,bhkd->bhqd", p, v_cache)
        return (lambda x, *d: x.permute(*d))(o, 0, 2, 1, 3).reshape(B, Sq, H * Dh) @ wo

    a = _A_ref(A_x, A_k_cache, A_v_cache, A_wq, A_wo)
    b = _B_ref(B_x, B_k_cache, B_v_cache, B_wq, B_wo)
    return torch.concatenate([a, b], axis=-1)
```

```asm
; @launch grid=(256,1,1) block=(512,1,1) lds=26624
.amdgcn_target "amdgcn-amd-amdhsa--gfx950"
.text
.p2align 12
.fill 128, 4, 0xbf810000
.globl concat_heads__sliding_block_cached__mha_block_cached__decode_kernel
.p2align 8
.type concat_heads__sliding_block_cached__mha_block_cached__decode_kernel,@function
concat_heads__sliding_block_cached__mha_block_cached__decode_kernel:
    s_load_dwordx16 s[16:31], s[0:1], 0
    v_readfirstlane_b32 s4, v0
    s_cmpk_ge_u32 s2, 256
    s_cbranch_scc1 L_end
    s_lshr_b32 s5, s2, 5
    s_mul_i32 s7, s5, 224
    v_and_b32 v0, 63, v0
    s_add_u32 s7, s7, s2
    s_addk_i32 s7, 192
    v_and_b32 v1, -16, v0
    s_lshl_b32 s7, s7, 8
    s_add_u32 s7, s7, s4
    v_add_lshl_u32 v1, v1, v0, 4
    v_lshl_add_u32 v62, s7, 6, v1
    s_cmpk_eq_u32 s4, 256
    s_cbranch_scc1 L_svcA
    s_cmpk_gt_u32 s4, 256
    s_cbranch_scc1 L_young
    s_waitcnt lgkmcnt(0)
    global_load_dwordx4 v[64:67], v62, s[18:19] offset:0 nt
    global_load_dwordx4 v[68:71], v62, s[18:19] offset:256 nt
    global_load_dwordx4 v[72:75], v62, s[18:19] offset:2048 nt
    global_load_dwordx4 v[76:79], v62, s[18:19] offset:2304 nt
L_young:
    s_load_dwordx8 s[32:39], s[0:1], 64
    s_load_dwordx2 s[40:41], s[0:1], 96
    s_lshr_b32 s4, s4, 6
    s_and_b32 s6, s2, 31
    s_mov_b32 s62, 1376256
    s_mov_b32 s63, 0x20000
    s_cmp_eq_u32 s4, 5
    s_cbranch_scc1 L_svcB
L_setup:
    s_lshr_b32 s97, s4, 2
    s_mul_i32 s97, s97, 288
    s_lshr_b32 s43, s2, 3
    s_lshl4_add_u32 s97, s43, s97
    s_and_b32 s7, s4, 3
    s_add_u32 s97, s97, s7
    s_and_b32 s7, s2, 7
    s_lshl2_add_u32 s97, s7, s97
    s_addk_i32 s97, 448
    s_lshl_b32 s97, s97, 12
    s_and_b32 s42, s97, 0x1fffff
    s_add_u32 s97, s97, 0x20000
    s_and_b32 s8, s97, 0x1fffff
    s_add_u32 s97, s97, 0x20000
    s_and_b32 s9, s97, 0x1fffff
    s_add_u32 s97, s97, 0x20000
    s_and_b32 s10, s97, 0x1fffff
    s_add_u32 s97, s97, 0x20000
    s_and_b32 s11, s97, 0x1fffff
    s_add_u32 s97, s97, 0x20000
    s_and_b32 s12, s97, 0x1fffff
    s_add_u32 s97, s97, 0x20000
    s_and_b32 s13, s97, 0x1fffff
    s_add_u32 s97, s97, 0x20000
    s_and_b32 s14, s97, 0x1fffff
    s_add_u32 s97, s97, 0x20000
    s_and_b32 s15, s97, 0x1fffff
    s_lshl_b32 s43, s43, 21
    s_mov_b32 s46, 0x200000
    s_mov_b32 s47, 0x20000
    s_mov_b32 s50, 0x200000
    s_mov_b32 s51, 0x20000
    s_waitcnt lgkmcnt(0)
    s_add_u32 s44, s28, s43
    s_addc_u32 s45, s29, 0
    s_add_u32 s48, s30, s43
    s_addc_u32 s49, s31, 0
    s_mov_b32 s60, s40
    s_mov_b32 s61, s41
    s_mov_b32 s96, 10
    s_cmp_lt_u32 s4, 4
    s_cbranch_scc1 L_old
    s_cmp_lt_u32 s4, 6
    s_cbranch_scc1 L_y1
    s_barrier
L_y1:
    s_barrier
    s_cmp_lt_u32 s96, 10
    s_cselect_b64 vcc, -1, 0
    s_cmp_ge_u32 s96, 18
    s_waitcnt vmcnt(6)
    s_cbranch_scc1 L_g1
    s_waitcnt vmcnt(4)
L_g1:
    buffer_load_dwordx4 v[64:67], v1, s[44:47], s42 offen offset:0 nt
    s_waitcnt vmcnt(6)
    s_cbranch_scc1 L_g2
    s_waitcnt vmcnt(4)
L_g2:
    buffer_load_dwordx4 v[68:71], v1, s[44:47], s42 offen offset:256 nt
    s_waitcnt vmcnt(6)
    s_cbranch_scc1 L_g3
    s_waitcnt vmcnt(4)
L_g3:
    buffer_load_dwordx4 v[72:75], v1, s[44:47], s42 offen offset:2048 nt
    s_waitcnt vmcnt(6)
    s_cbranch_scc1 L_g4
    s_waitcnt vmcnt(4)
L_g4:
    buffer_load_dwordx4 v[76:79], v1, s[44:47], s42 offen offset:2304 nt
    s_waitcnt vmcnt(6)
    s_cbranch_scc1 L_g5
    s_waitcnt vmcnt(4)
L_g5:
    buffer_load_dwordx4 v[80:83], v1, s[44:47], s8 offen offset:0 nt
    s_waitcnt vmcnt(6)
    s_cbranch_scc1 L_g6
    s_waitcnt vmcnt(4)
L_g6:
    buffer_load_dwordx4 v[84:87], v1, s[44:47], s8 offen offset:256 nt
    s_waitcnt vmcnt(6)
    s_cbranch_scc1 L_g7
    s_waitcnt vmcnt(4)
L_g7:
    buffer_load_dwordx4 v[88:91], v1, s[44:47], s8 offen offset:2048 nt
    s_waitcnt vmcnt(6)
    s_cbranch_scc1 L_g8
    s_waitcnt vmcnt(4)
L_g8:
    buffer_load_dwordx4 v[92:95], v1, s[44:47], s8 offen offset:2304 nt
    s_branch L_kcommon
L_old:
    v_add_u32 v63, 0x80000, v62
    s_barrier
    global_load_dwordx4 v[80:83], v63, s[18:19] offset:0 nt
    global_load_dwordx4 v[84:87], v63, s[18:19] offset:256 nt
    s_waitcnt vmcnt(4)
    global_load_dwordx4 v[88:91], v63, s[18:19] offset:2048 nt
    s_waitcnt vmcnt(4)
    global_load_dwordx4 v[92:95], v63, s[18:19] offset:2304 nt
    s_waitcnt vmcnt(4)
    global_load_dwordx4 v[208:211], v62, s[20:21] offset:0 nt
    s_waitcnt vmcnt(4)
    global_load_dwordx4 v[212:215], v62, s[20:21] offset:256 nt
    s_waitcnt vmcnt(4)
    global_load_dwordx4 v[216:219], v62, s[20:21] offset:2048 nt
    s_waitcnt vmcnt(4)
    global_load_dwordx4 v[220:223], v62, s[20:21] offset:2304 nt
    s_waitcnt vmcnt(4)
    global_load_dwordx4 v[224:227], v63, s[20:21] offset:0 nt
    s_waitcnt vmcnt(4)
    global_load_dwordx4 v[228:231], v63, s[20:21] offset:256 nt
    s_waitcnt vmcnt(4)
    global_load_dwordx4 v[232:235], v63, s[20:21] offset:2048 nt
    s_waitcnt vmcnt(4)
    global_load_dwordx4 v[236:239], v63, s[20:21] offset:2304 nt
L_kcommon:
    v_mov_b32 v60, 1548
    ds_read_b32 v61, v60
    s_waitcnt lgkmcnt(0)
    v_readfirstlane_b32 s96, v61
    s_nop 1
    s_cmp_lt_u32 s96, 10
    s_cselect_b64 vcc, -1, 0
    s_cmp_ge_u32 s96, 18
    s_waitcnt vmcnt(6)
    s_cbranch_scc1 L_g9
    s_waitcnt vmcnt(4)
L_g9:
    buffer_load_dwordx4 v[96:99], v1, s[44:47], s9 offen offset:0 nt
    s_waitcnt vmcnt(6)
    s_cbranch_scc1 L_g10
    s_waitcnt vmcnt(4)
L_g10:
    buffer_load_dwordx4 v[100:103], v1, s[44:47], s9 offen offset:256 nt
    s_waitcnt vmcnt(6)
    s_cbranch_scc1 L_g11
    s_waitcnt vmcnt(4)
L_g11:
    buffer_load_dwordx4 v[104:107], v1, s[44:47], s9 offen offset:2048 nt
    s_waitcnt vmcnt(6)
    s_cbranch_scc1 L_g12
    s_waitcnt vmcnt(4)
L_g12:
    buffer_load_dwordx4 v[108:111], v1, s[44:47], s9 offen offset:2304 nt
    s_waitcnt vmcnt(6)
    s_cbranch_scc1 L_g13
    s_waitcnt vmcnt(4)
L_g13:
    buffer_load_dwordx4 v[112:115], v1, s[44:47], s10 offen offset:0 nt
    s_waitcnt vmcnt(6)
    s_cbranch_scc1 L_g14
    s_waitcnt vmcnt(4)
L_g14:
    buffer_load_dwordx4 v[116:119], v1, s[44:47], s10 offen offset:256 nt
    s_waitcnt vmcnt(6)
    s_cbranch_scc1 L_g15
    s_waitcnt vmcnt(4)
L_g15:
    buffer_load_dwordx4 v[120:123], v1, s[44:47], s10 offen offset:2048 nt
    s_waitcnt vmcnt(6)
    s_cbranch_scc1 L_g16
    s_waitcnt vmcnt(4)
L_g16:
    buffer_load_dwordx4 v[124:127], v1, s[44:47], s10 offen offset:2304 nt
    v_mov_b32 v60, 1548
    ds_read_b32 v61, v60
    s_waitcnt lgkmcnt(0)
    v_readfirstlane_b32 s96, v61
    s_nop 1
    s_cmp_lt_u32 s96, 10
    s_cselect_b64 vcc, -1, 0
    s_cmp_ge_u32 s96, 18
    s_waitcnt vmcnt(6)
    s_cbranch_scc1 L_g17
    s_waitcnt vmcnt(4)
L_g17:
    buffer_load_dwordx4 v[128:131], v1, s[44:47], s11 offen offset:0 nt
    s_waitcnt vmcnt(6)
    s_cbranch_scc1 L_g18
    s_waitcnt vmcnt(4)
L_g18:
    buffer_load_dwordx4 v[132:135], v1, s[44:47], s11 offen offset:256 nt
    s_waitcnt vmcnt(6)
    s_cbranch_scc1 L_g19
    s_waitcnt vmcnt(4)
L_g19:
    buffer_load_dwordx4 v[136:139], v1, s[44:47], s11 offen offset:2048 nt
    s_waitcnt vmcnt(6)
    s_cbranch_scc1 L_g20
    s_waitcnt vmcnt(4)
L_g20:
    buffer_load_dwordx4 v[140:143], v1, s[44:47], s11 offen offset:2304 nt
    s_waitcnt vmcnt(6)
    s_cbranch_scc1 L_g21
    s_waitcnt vmcnt(4)
L_g21:
    buffer_load_dwordx4 v[144:147], v1, s[44:47], s12 offen offset:0 nt
    s_waitcnt vmcnt(6)
    s_cbranch_scc1 L_g22
    s_waitcnt vmcnt(4)
L_g22:
    buffer_load_dwordx4 v[148:151], v1, s[44:47], s12 offen offset:256 nt
    s_waitcnt vmcnt(6)
    s_cbranch_scc1 L_g23
    s_waitcnt vmcnt(4)
L_g23:
    buffer_load_dwordx4 v[152:155], v1, s[44:47], s12 offen offset:2048 nt
    s_waitcnt vmcnt(6)
    s_cbranch_scc1 L_g24
    s_waitcnt vmcnt(4)
L_g24:
    buffer_load_dwordx4 v[156:159], v1, s[44:47], s12 offen offset:2304 nt
    s_waitcnt vmcnt(6)
    s_cbranch_scc1 L_g25
    s_waitcnt vmcnt(4)
L_g25:
    buffer_load_dwordx4 v[160:163], v1, s[44:47], s13 offen offset:0 nt
    s_waitcnt vmcnt(6)
    s_cbranch_scc1 L_g26
    s_waitcnt vmcnt(4)
L_g26:
    buffer_load_dwordx4 v[164:167], v1, s[44:47], s13 offen offset:256 nt
    s_waitcnt vmcnt(6)
    s_cbranch_scc1 L_g27
    s_waitcnt vmcnt(4)
L_g27:
    buffer_load_dwordx4 v[168:171], v1, s[44:47], s13 offen offset:2048 nt
    s_waitcnt vmcnt(6)
    s_cbranch_scc1 L_g28
    s_waitcnt vmcnt(4)
L_g28:
    buffer_load_dwordx4 v[172:175], v1, s[44:47], s13 offen offset:2304 nt
    s_waitcnt vmcnt(6)
    s_cbranch_scc1 L_g29
    s_waitcnt vmcnt(4)
L_g29:
    buffer_load_dwordx4 v[176:179], v1, s[44:47], s14 offen offset:0 nt
    s_waitcnt vmcnt(6)
    s_cbranch_scc1 L_g30
    s_waitcnt vmcnt(4)
L_g30:
    buffer_load_dwordx4 v[180:183], v1, s[44:47], s14 offen offset:256 nt
    s_waitcnt vmcnt(6)
    s_cbranch_scc1 L_g31
    s_waitcnt vmcnt(4)
L_g31:
    buffer_load_dwordx4 v[184:187], v1, s[44:47], s14 offen offset:2048 nt
    s_waitcnt vmcnt(6)
    s_cbranch_scc1 L_g32
    s_waitcnt vmcnt(4)
L_g32:
    buffer_load_dwordx4 v[188:191], v1, s[44:47], s14 offen offset:2304 nt
    s_waitcnt vmcnt(6)
    s_cbranch_scc1 L_g33
    s_waitcnt vmcnt(4)
L_g33:
    buffer_load_dwordx4 v[192:195], v1, s[44:47], s15 offen offset:0 nt
    s_waitcnt vmcnt(6)
    s_cbranch_scc1 L_g34
    s_waitcnt vmcnt(4)
L_g34:
    buffer_load_dwordx4 v[196:199], v1, s[44:47], s15 offen offset:256 nt
    s_waitcnt vmcnt(6)
    s_cbranch_scc1 L_g35
    s_waitcnt vmcnt(4)
L_g35:
    buffer_load_dwordx4 v[200:203], v1, s[44:47], s15 offen offset:2048 nt
    s_waitcnt vmcnt(6)
    s_cbranch_scc1 L_g36
    s_waitcnt vmcnt(4)
L_g36:
    buffer_load_dwordx4 v[204:207], v1, s[44:47], s15 offen offset:2304 nt
    s_barrier
    s_cmp_ge_u32 s4, 4
    s_cselect_b64 s[90:91], -1, 0
    s_cselect_b32 s7, 0, 512
    v_and_b32 v30, 15, v0
    v_lshlrev_b32 v30, 4, v30
    v_add_u32 v29, s7, v30
    v_add_u32 v28, s7, v29
    ds_read_b128 v[32:35], v30
    ds_read_b128 v[36:39], v30 offset:256
    ds_read_b128 v[40:43], v29
    ds_read_b128 v[44:47], v29 offset:256
    ds_read_b128 v[48:51], v28
    ds_read_b128 v[52:55], v28 offset:256
    v_and_b32 v2, 1, v0
    v_lshlrev_b32 v2, 4, v2
    v_mov_b32 v3, 0xffff
    v_lshlrev_b32 v2, v2, v3
    v_bfe_u32 v3, v0, 1, 2
    v_cmp_eq_u32 vcc, 0, v3
    s_nop 1
    v_cndmask_b32 v4, 0, v2, vcc
    v_cmp_eq_u32 vcc, 1, v3
    s_nop 1
    v_cndmask_b32 v5, 0, v2, vcc
    v_cmp_eq_u32 vcc, 2, v3
    s_nop 1
    v_cndmask_b32 v6, 0, v2, vcc
    v_cmp_eq_u32 vcc, 3, v3
    s_nop 1
    v_cndmask_b32 v7, 0, v2, vcc
    s_mov_b32 s84, 0x3db8aa3b
    s_waitcnt lgkmcnt(0)
    s_lshr_b32 s87, s4, 2
    s_and_b32 s7, s4, 3
    s_cbranch_scc1 L_mk1
    s_and_b32 s7, s2, -32
    s_add_u32 s7, s7, s87
    s_mul_i32 s7, s7, 3584
    s_add_u32 s94, s40, s7
    s_addc_u32 s95, s41, 0
    s_cmp_lt_u32 s6, 8
    s_cbranch_scc1 L_mw1
    s_load_dword s93, s[94:95], 3456 glc
    s_branch L_mk1
L_mw1:
    s_mov_b32 s93, 1
    s_atomic_add s93, s[94:95], 3456 glc
L_mk1:
    s_waitcnt vmcnt(32)
    v_mov_b32 v56, 0
    v_mov_b32 v57, 0
    v_mov_b32 v58, 0
    v_mov_b32 v59, 0
    v_dot2c_f32_bf16 v56, v64, v40
    v_dot2c_f32_bf16 v57, v64, v48
    v_dot2c_f32_bf16 v58, v72, v40
    v_dot2c_f32_bf16 v59, v72, v48
    v_dot2c_f32_bf16 v56, v65, v41
    v_dot2c_f32_bf16 v57, v65, v49
    v_dot2c_f32_bf16 v58, v73, v41
    v_dot2c_f32_bf16 v59, v73, v49
    v_dot2c_f32_bf16 v56, v66, v42
    v_dot2c_f32_bf16 v57, v66, v50
    v_dot2c_f32_bf16 v58, v74, v42
    v_dot2c_f32_bf16 v59, v74, v50
    v_dot2c_f32_bf16 v56, v67, v43
    v_dot2c_f32_bf16 v57, v67, v51
    v_dot2c_f32_bf16 v58, v75, v43
    v_dot2c_f32_bf16 v59, v75, v51
    v_dot2c_f32_bf16 v56, v68, v44
    v_dot2c_f32_bf16 v57, v68, v52
    v_dot2c_f32_bf16 v58, v76, v44
    v_dot2c_f32_bf16 v59, v76, v52
    v_dot2c_f32_bf16 v56, v69, v45
    v_dot2c_f32_bf16 v57, v69, v53
    v_dot2c_f32_bf16 v58, v77, v45
    v_dot2c_f32_bf16 v59, v77, v53
    v_dot2c_f32_bf16 v56, v70, v46
    v_dot2c_f32_bf16 v57, v70, v54
    v_dot2c_f32_bf16 v58, v78, v46
    v_dot2c_f32_bf16 v59, v78, v54
    v_dot2c_f32_bf16 v56, v71, v47
    v_dot2c_f32_bf16 v57, v71, v55
    v_dot2c_f32_bf16 v58, v79, v47
    v_dot2c_f32_bf16 v59, v79, v55
    v_add_f32_dpp v8, v56, v56 row_ror:8 row_mask:0xf bank_mask:0x3
    s_nop 0
    v_add_f32_dpp v9, v58, v58 row_ror:8 row_mask:0xf bank_mask:0x3
    v_add_f32_dpp v8, v57, v57 row_ror:8 row_mask:0xf bank_mask:0xc
    s_nop 0
    v_add_f32_dpp v9, v59, v59 row_ror:8 row_mask:0xf bank_mask:0xc
    v_add_f32_dpp v8, v8, v8 row_half_mirror row_mask:0xf bank_mask:0xf
    s_nop 0
    v_add_f32_dpp v9, v9, v9 row_half_mirror row_mask:0xf bank_mask:0xf
    v_add_f32_dpp v8, v8, v8 quad_perm:[2,3,0,1] row_mask:0xf bank_mask:0xf
    s_nop 0
    v_add_f32_dpp v9, v9, v9 quad_perm:[2,3,0,1] row_mask:0xf bank_mask:0xf
    v_add_f32_dpp v8, v8, v8 quad_perm:[1,0,3,2] row_mask:0xf bank_mask:0xf
    s_nop 0
    v_add_f32_dpp v9, v9, v9 quad_perm:[1,0,3,2] row_mask:0xf bank_mask:0xf
    v_cvt_pk_bf16_f32 v9, v8, v9
    v_lshlrev_b32 v8, 16, v9
    v_and_b32 v9, 0xffff0000, v9
    s_waitcnt vmcnt(28)
    v_mov_b32 v60, 0
    v_mov_b32 v61, 0
    v_mov_b32 v62, 0
    v_mov_b32 v63, 0
    v_dot2c_f32_bf16 v60, v80, v40
    v_dot2c_f32_bf16 v61, v80, v48
    v_dot2c_f32_bf16 v62, v88, v40
    v_dot2c_f32_bf16 v63, v88, v48
    v_dot2c_f32_bf16 v60, v81, v41
    v_dot2c_f32_bf16 v61, v81, v49
    v_dot2c_f32_bf16 v62, v89, v41
    v_dot2c_f32_bf16 v63, v89, v49
    v_dot2c_f32_bf16 v60, v82, v42
    v_dot2c_f32_bf16 v61, v82, v50
    v_dot2c_f32_bf16 v62, v90, v42
    v_dot2c_f32_bf16 v63, v90, v50
    v_dot2c_f32_bf16 v60, v83, v43
    v_dot2c_f32_bf16 v61, v83, v51
    v_dot2c_f32_bf16 v62, v91, v43
    v_dot2c_f32_bf16 v63, v91, v51
    v_dot2c_f32_bf16 v60, v84, v44
    v_dot2c_f32_bf16 v61, v84, v52
    v_dot2c_f32_bf16 v62, v92, v44
    v_dot2c_f32_bf16 v63, v92, v52
    v_dot2c_f32_bf16 v60, v85, v45
    v_dot2c_f32_bf16 v61, v85, v53
    v_dot2c_f32_bf16 v62, v93, v45
    v_dot2c_f32_bf16 v63, v93, v53
    v_dot2c_f32_bf16 v60, v86, v46
    v_dot2c_f32_bf16 v61, v86, v54
    v_dot2c_f32_bf16 v62, v94, v46
    v_dot2c_f32_bf16 v63, v94, v54
    v_dot2c_f32_bf16 v60, v87, v47
    v_dot2c_f32_bf16 v61, v87, v55
    v_dot2c_f32_bf16 v62, v95, v47
    v_dot2c_f32_bf16 v63, v95, v55
    v_add_f32_dpp v10, v60, v60 row_ror:8 row_mask:0xf bank_mask:0x3
    s_nop 0
    v_add_f32_dpp v11, v62, v62 row_ror:8 row_mask:0xf bank_mask:0x3
    v_add_f32_dpp v10, v61, v61 row_ror:8 row_mask:0xf bank_mask:0xc
    s_nop 0
    v_add_f32_dpp v11, v63, v63 row_ror:8 row_mask:0xf bank_mask:0xc
    v_add_f32_dpp v10, v10, v10 row_half_mirror row_mask:0xf bank_mask:0xf
    s_nop 0
    v_add_f32_dpp v11, v11, v11 row_half_mirror row_mask:0xf bank_mask:0xf
    v_add_f32_dpp v10, v10, v10 quad_perm:[2,3,0,1] row_mask:0xf bank_mask:0xf
    s_nop 0
    v_add_f32_dpp v11, v11, v11 quad_perm:[2,3,0,1] row_mask:0xf bank_mask:0xf
    v_add_f32_dpp v10, v10, v10 quad_perm:[1,0,3,2] row_mask:0xf bank_mask:0xf
    s_nop 0
    v_add_f32_dpp v11, v11, v11 quad_perm:[1,0,3,2] row_mask:0xf bank_mask:0xf
    v_cvt_pk_bf16_f32 v11, v10, v11
    v_lshlrev_b32 v10, 16, v11
    v_and_b32 v11, 0xffff0000, v11
    s_waitcnt vmcnt(24)
    v_mov_b32 v56, 0
    v_mov_b32 v57, 0
    v_dot2c_f32_bf16 v56, v96, v32
    v_dot2c_f32_bf16 v57, v104, v32
    v_dot2c_f32_bf16 v56, v97, v33
    v_dot2c_f32_bf16 v57, v105, v33
    v_dot2c_f32_bf16 v56, v98, v34
    v_dot2c_f32_bf16 v57, v106, v34
    v_dot2c_f32_bf16 v56, v99, v35
    v_dot2c_f32_bf16 v57, v107, v35
    v_dot2c_f32_bf16 v56, v100, v36
    v_dot2c_f32_bf16 v57, v108, v36
    v_dot2c_f32_bf16 v56, v101, v37
    v_dot2c_f32_bf16 v57, v109, v37
    v_dot2c_f32_bf16 v56, v102, v38
    v_dot2c_f32_bf16 v57, v110, v38
    v_dot2c_f32_bf16 v56, v103, v39
    v_dot2c_f32_bf16 v57, v111, v39
    s_nop 1
    v_add_f32_dpp v12, v56, v56 row_ror:8 row_mask:0xf bank_mask:0xf
    v_add_f32_dpp v13, v57, v57 row_ror:8 row_mask:0xf bank_mask:0xf
    s_nop 0
    v_add_f32_dpp v12, v12, v12 row_half_mirror row_mask:0xf bank_mask:0xf
    v_add_f32_dpp v13, v13, v13 row_half_mirror row_mask:0xf bank_mask:0xf
    s_nop 0
    v_add_f32_dpp v12, v12, v12 quad_perm:[2,3,0,1] row_mask:0xf bank_mask:0xf
    v_add_f32_dpp v13, v13, v13 quad_perm:[2,3,0,1] row_mask:0xf bank_mask:0xf
    s_nop 0
    v_add_f32_dpp v12, v12, v12 quad_perm:[1,0,3,2] row_mask:0xf bank_mask:0xf
    v_add_f32_dpp v13, v13, v13 quad_perm:[1,0,3,2] row_mask:0xf bank_mask:0xf
    v_cvt_pk_bf16_f32 v13, v12, v13
    v_lshlrev_b32 v12, 16, v13
    v_and_b32 v13, 0xffff0000, v13
    s_waitcnt vmcnt(20)
    v_mov_b32 v60, 0
    v_mov_b32 v61, 0
    v_dot2c_f32_bf16 v60, v112, v32
    v_dot2c_f32_bf16 v61, v120, v32
    v_dot2c_f32_bf16 v60, v113, v33
    v_dot2c_f32_bf16 v61, v121, v33
    v_dot2c_f32_bf16 v60, v114, v34
    v_dot2c_f32_bf16 v61, v122, v34
    v_dot2c_f32_bf16 v60, v115, v35
    v_dot2c_f32_bf16 v61, v123, v35
    v_dot2c_f32_bf16 v60, v116, v36
    v_dot2c_f32_bf16 v61, v124, v36
    v_dot2c_f32_bf16 v60, v117, v37
    v_dot2c_f32_bf16 v61, v125, v37
    v_dot2c_f32_bf16 v60, v118, v38
    v_dot2c_f32_bf16 v61, v126, v38
    v_dot2c_f32_bf16 v60, v119, v39
    v_dot2c_f32_bf16 v61, v127, v39
    s_nop 1
    v_add_f32_dpp v14, v60, v60 row_ror:8 row_mask:0xf bank_mask:0xf
    v_add_f32_dpp v15, v61, v61 row_ror:8 row_mask:0xf bank_mask:0xf
    s_nop 0
    v_add_f32_dpp v14, v14, v14 row_half_mirror row_mask:0xf bank_mask:0xf
    v_add_f32_dpp v15, v15, v15 row_half_mirror row_mask:0xf bank_mask:0xf
    s_nop 0
    v_add_f32_dpp v14, v14, v14 quad_perm:[2,3,0,1] row_mask:0xf bank_mask:0xf
    v_add_f32_dpp v15, v15, v15 quad_perm:[2,3,0,1] row_mask:0xf bank_mask:0xf
    s_nop 0
    v_add_f32_dpp v14, v14, v14 quad_perm:[1,0,3,2] row_mask:0xf bank_mask:0xf
    v_add_f32_dpp v15, v15, v15 quad_perm:[1,0,3,2] row_mask:0xf bank_mask:0xf
    v_cvt_pk_bf16_f32 v15, v14, v15
    v_lshlrev_b32 v14, 16, v15
    v_and_b32 v15, 0xffff0000, v15
    s_waitcnt vmcnt(16)
    v_mov_b32 v56, 0
    v_mov_b32 v57, 0
    v_dot2c_f32_bf16 v56, v128, v32
    v_dot2c_f32_bf16 v57, v136, v32
    v_dot2c_f32_bf16 v56, v129, v33
    v_dot2c_f32_bf16 v57, v137, v33
    v_dot2c_f32_bf16 v56, v130, v34
    v_dot2c_f32_bf16 v57, v138, v34
    v_dot2c_f32_bf16 v56, v131, v35
    v_dot2c_f32_bf16 v57, v139, v35
    v_dot2c_f32_bf16 v56, v132, v36
    v_dot2c_f32_bf16 v57, v140, v36
    v_dot2c_f32_bf16 v56, v133, v37
    v_dot2c_f32_bf16 v57, v141, v37
    v_dot2c_f32_bf16 v56, v134, v38
    v_dot2c_f32_bf16 v57, v142, v38
    v_dot2c_f32_bf16 v56, v135, v39
    v_dot2c_f32_bf16 v57, v143, v39
    s_nop 1
    v_add_f32_dpp v16, v56, v56 row_ror:8 row_mask:0xf bank_mask:0xf
    v_add_f32_dpp v17, v57, v57 row_ror:8 row_mask:0xf bank_mask:0xf
    s_nop 0
    v_add_f32_dpp v16, v16, v16 row_half_mirror row_mask:0xf bank_mask:0xf
    v_add_f32_dpp v17, v17, v17 row_half_mirror row_mask:0xf bank_mask:0xf
    s_nop 0
    v_add_f32_dpp v16, v16, v16 quad_perm:[2,3,0,1] row_mask:0xf bank_mask:0xf
    v_add_f32_dpp v17, v17, v17 quad_perm:[2,3,0,1] row_mask:0xf bank_mask:0xf
    s_nop 0
    v_add_f32_dpp v16, v16, v16 quad_perm:[1,0,3,2] row_mask:0xf bank_mask:0xf
    v_add_f32_dpp v17, v17, v17 quad_perm:[1,0,3,2] row_mask:0xf bank_mask:0xf
    v_cvt_pk_bf16_f32 v17, v16, v17
    v_lshlrev_b32 v16, 16, v17
    v_and_b32 v17, 0xffff0000, v17
    s_waitcnt vmcnt(12)
    v_mov_b32 v60, 0
    v_mov_b32 v61, 0
    v_dot2c_f32_bf16 v60, v144, v32
    v_dot2c_f32_bf16 v61, v152, v32
    v_dot2c_f32_bf16 v60, v145, v33
    v_dot2c_f32_bf16 v61, v153, v33
    v_dot2c_f32_bf16 v60, v146, v34
    v_dot2c_f32_bf16 v61, v154, v34
    v_dot2c_f32_bf16 v60, v147, v35
    v_dot2c_f32_bf16 v61, v155, v35
    v_dot2c_f32_bf16 v60, v148, v36
    v_dot2c_f32_bf16 v61, v156, v36
    v_dot2c_f32_bf16 v60, v149, v37
    v_dot2c_f32_bf16 v61, v157, v37
    v_dot2c_f32_bf16 v60, v150, v38
    v_dot2c_f32_bf16 v61, v158, v38
    v_dot2c_f32_bf16 v60, v151, v39
    v_dot2c_f32_bf16 v61, v159, v39
    s_nop 1
    v_add_f32_dpp v18, v60, v60 row_ror:8 row_mask:0xf bank_mask:0xf
    v_add_f32_dpp v19, v61, v61 row_ror:8 row_mask:0xf bank_mask:0xf
    s_nop 0
    v_add_f32_dpp v18, v18, v18 row_half_mirror row_mask:0xf bank_mask:0xf
    v_add_f32_dpp v19, v19, v19 row_half_mirror row_mask:0xf bank_mask:0xf
    s_nop 0
    v_add_f32_dpp v18, v18, v18 quad_perm:[2,3,0,1] row_mask:0xf bank_mask:0xf
    v_add_f32_dpp v19, v19, v19 quad_perm:[2,3,0,1] row_mask:0xf bank_mask:0xf
    s_nop 0
    v_add_f32_dpp v18, v18, v18 quad_perm:[1,0,3,2] row_mask:0xf bank_mask:0xf
    v_add_f32_dpp v19, v19, v19 quad_perm:[1,0,3,2] row_mask:0xf bank_mask:0xf
    v_cvt_pk_bf16_f32 v19, v18, v19
    v_lshlrev_b32 v18, 16, v19
    v_and_b32 v19, 0xffff0000, v19
    s_waitcnt vmcnt(8)
    v_mov_b32 v56, 0
    v_mov_b32 v57, 0
    v_dot2c_f32_bf16 v56, v160, v32
    v_dot2c_f32_bf16 v57, v168, v32
    v_dot2c_f32_bf16 v56, v161, v33
    v_dot2c_f32_bf16 v57, v169, v33
    v_dot2c_f32_bf16 v56, v162, v34
    v_dot2c_f32_bf16 v57, v170, v34
    v_dot2c_f32_bf16 v56, v163, v35
    v_dot2c_f32_bf16 v57, v171, v35
    v_dot2c_f32_bf16 v56, v164, v36
    v_dot2c_f32_bf16 v57, v172, v36
    v_dot2c_f32_bf16 v56, v165, v37
    v_dot2c_f32_bf16 v57, v173, v37
    v_dot2c_f32_bf16 v56, v166, v38
    v_dot2c_f32_bf16 v57, v174, v38
    v_dot2c_f32_bf16 v56, v167, v39
    v_dot2c_f32_bf16 v57, v175, v39
    s_nop 1
    v_add_f32_dpp v20, v56, v56 row_ror:8 row_mask:0xf bank_mask:0xf
    v_add_f32_dpp v21, v57, v57 row_ror:8 row_mask:0xf bank_mask:0xf
    s_nop 0
    v_add_f32_dpp v20, v20, v20 row_half_mirror row_mask:0xf bank_mask:0xf
    v_add_f32_dpp v21, v21, v21 row_half_mirror row_mask:0xf bank_mask:0xf
    s_nop 0
    v_add_f32_dpp v20, v20, v20 quad_perm:[2,3,0,1] row_mask:0xf bank_mask:0xf
    v_add_f32_dpp v21, v21, v21 quad_perm:[2,3,0,1] row_mask:0xf bank_mask:0xf
    s_nop 0
    v_add_f32_dpp v20, v20, v20 quad_perm:[1,0,3,2] row_mask:0xf bank_mask:0xf
    v_add_f32_dpp v21, v21, v21 quad_perm:[1,0,3,2] row_mask:0xf bank_mask:0xf
    v_cvt_pk_bf16_f32 v21, v20, v21
    v_lshlrev_b32 v20, 16, v21
    v_and_b32 v21, 0xffff0000, v21
    s_waitcnt vmcnt(4)
    v_mov_b32 v60, 0
    v_mov_b32 v61, 0
    v_dot2c_f32_bf16 v60, v176, v32
    v_dot2c_f32_bf16 v61, v184, v32
    v_dot2c_f32_bf16 v60, v177, v33
    v_dot2c_f32_bf16 v61, v185, v33
    v_dot2c_f32_bf16 v60, v178, v34
    v_dot2c_f32_bf16 v61, v186, v34
    v_dot2c_f32_bf16 v60, v179, v35
    v_dot2c_f32_bf16 v61, v187, v35
    v_dot2c_f32_bf16 v60, v180, v36
    v_dot2c_f32_bf16 v61, v188, v36
    v_dot2c_f32_bf16 v60, v181, v37
    v_dot2c_f32_bf16 v61, v189, v37
    v_dot2c_f32_bf16 v60, v182, v38
    v_dot2c_f32_bf16 v61, v190, v38
    v_dot2c_f32_bf16 v60, v183, v39
    v_dot2c_f32_bf16 v61, v191, v39
    s_nop 1
    v_add_f32_dpp v22, v60, v60 row_ror:8 row_mask:0xf bank_mask:0xf
    v_add_f32_dpp v23, v61, v61 row_ror:8 row_mask:0xf bank_mask:0xf
    s_nop 0
    v_add_f32_dpp v22, v22, v22 row_half_mirror row_mask:0xf bank_mask:0xf
    v_add_f32_dpp v23, v23, v23 row_half_mirror row_mask:0xf bank_mask:0xf
    s_nop 0
    v_add_f32_dpp v22, v22, v22 quad_perm:[2,3,0,1] row_mask:0xf bank_mask:0xf
    v_add_f32_dpp v23, v23, v23 quad_perm:[2,3,0,1] row_mask:0xf bank_mask:0xf
    s_nop 0
    v_add_f32_dpp v22, v22, v22 quad_perm:[1,0,3,2] row_mask:0xf bank_mask:0xf
    v_add_f32_dpp v23, v23, v23 quad_perm:[1,0,3,2] row_mask:0xf bank_mask:0xf
    v_cvt_pk_bf16_f32 v23, v22, v23
    v_lshlrev_b32 v22, 16, v23
    v_and_b32 v23, 0xffff0000, v23
    s_waitcnt vmcnt(0)
    v_mov_b32 v56, 0
    v_mov_b32 v57, 0
    v_dot2c_f32_bf16 v56, v192, v32
    v_dot2c_f32_bf16 v57, v200, v32
    v_dot2c_f32_bf16 v56, v193, v33
    v_dot2c_f32_bf16 v57, v201, v33
    v_dot2c_f32_bf16 v56, v194, v34
    v_dot2c_f32_bf16 v57, v202, v34
    v_dot2c_f32_bf16 v56, v195, v35
    v_dot2c_f32_bf16 v57, v203, v35
    v_dot2c_f32_bf16 v56, v196, v36
    v_dot2c_f32_bf16 v57, v204, v36
    v_dot2c_f32_bf16 v56, v197, v37
    v_dot2c_f32_bf16 v57, v205, v37
    v_dot2c_f32_bf16 v56, v198, v38
    v_dot2c_f32_bf16 v57, v206, v38
    v_dot2c_f32_bf16 v56, v199, v39
    v_dot2c_f32_bf16 v57, v207, v39
    s_nop 1
    v_add_f32_dpp v24, v56, v56 row_ror:8 row_mask:0xf bank_mask:0xf
    v_add_f32_dpp v25, v57, v57 row_ror:8 row_mask:0xf bank_mask:0xf
    s_nop 0
    v_add_f32_dpp v24, v24, v24 row_half_mirror row_mask:0xf bank_mask:0xf
    v_add_f32_dpp v25, v25, v25 row_half_mirror row_mask:0xf bank_mask:0xf
    s_nop 0
    v_add_f32_dpp v24, v24, v24 quad_perm:[2,3,0,1] row_mask:0xf bank_mask:0xf
    v_add_f32_dpp v25, v25, v25 quad_perm:[2,3,0,1] row_mask:0xf bank_mask:0xf
    s_nop 0
    v_add_f32_dpp v24, v24, v24 quad_perm:[1,0,3,2] row_mask:0xf bank_mask:0xf
    v_add_f32_dpp v25, v25, v25 quad_perm:[1,0,3,2] row_mask:0xf bank_mask:0xf
    v_cvt_pk_bf16_f32 v25, v24, v25
    v_lshlrev_b32 v24, 16, v25
    v_and_b32 v25, 0xffff0000, v25
    s_and_b32 s7, s4, 3
    s_cbranch_scc1 L_ps1
    s_waitcnt lgkmcnt(0)
    s_lshl2_add_u32 s93, s93, 5
    v_mov_b32 v60, 1548
    v_mov_b32 v61, s93
    ds_write_b32 v60, v61
L_ps1:
    v_max3_f32 v26, v8, v9, v10
    v_max_f32 v26, v26, v11
    v_max_f32 v28, v12, v13
    v_max3_f32 v28, v28, v14, v15
    v_max3_f32 v28, v28, v16, v17
    v_max3_f32 v28, v28, v18, v19
    v_max3_f32 v28, v28, v20, v21
    v_max3_f32 v28, v28, v22, v23
    v_max3_f32 v28, v28, v24, v25
    v_mov_b32 v56, v26
    v_mov_b32 v57, v28
    s_nop 0
    v_permlane16_swap_b32 v26, v56
    v_permlane16_swap_b32 v28, v57
    v_max_f32 v26, v26, v56
    v_max_f32 v28, v28, v57
    v_mov_b32 v56, v26
    v_mov_b32 v57, v28
    s_nop 0
    v_permlane32_swap_b32 v26, v56
    v_permlane32_swap_b32 v28, v57
    v_max_f32 v26, v26, v56
    v_max_f32 v28, v28, v57
    v_max_f32 v56, v26, v28
    v_cndmask_b32_e64 v26, v26, v56, s[90:91]
    v_cndmask_b32_e64 v28, v28, v56, s[90:91]
    v_mul_f32 v26, s84, v26
    v_mul_f32 v28, s84, v28
    v_fma_f32 v8, v8, s84, -v26
    v_fma_f32 v9, v9, s84, -v26
    v_fma_f32 v10, v10, s84, -v26
    v_fma_f32 v11, v11, s84, -v26
    v_fma_f32 v12, v12, s84, -v28
    v_fma_f32 v13, v13, s84, -v28
    v_fma_f32 v14, v14, s84, -v28
    v_fma_f32 v15, v15, s84, -v28
    v_fma_f32 v16, v16, s84, -v28
    v_fma_f32 v17, v17, s84, -v28
    v_fma_f32 v18, v18, s84, -v28
    v_fma_f32 v19, v19, s84, -v28
    v_fma_f32 v20, v20, s84, -v28
    v_fma_f32 v21, v21, s84, -v28
    v_fma_f32 v22, v22, s84, -v28
    v_fma_f32 v23, v23, s84, -v28
    v_fma_f32 v24, v24, s84, -v28
    v_fma_f32 v25, v25, s84, -v28
    v_exp_f32 v8, v8
    v_exp_f32 v9, v9
    v_exp_f32 v10, v10
    v_exp_f32 v11, v11
    v_exp_f32 v12, v12
    v_exp_f32 v13, v13
    v_exp_f32 v14, v14
    v_exp_f32 v15, v15
    v_exp_f32 v16, v16
    v_exp_f32 v17, v17
    v_exp_f32 v18, v18
    v_exp_f32 v19, v19
    v_exp_f32 v20, v20
    v_exp_f32 v21, v21
    v_exp_f32 v22, v22
    v_exp_f32 v23, v23
    v_exp_f32 v24, v24
    v_exp_f32 v25, v25
    v_add_f32 v27, v8, v9
    v_add_f32 v30, v10, v11
    v_add_f32 v27, v27, v30
    v_add_f32 v29, v12, v13
    v_add_f32 v30, v14, v15
    v_add_f32 v29, v29, v16
    v_add_f32 v30, v30, v17
    v_add_f32 v29, v29, v18
    v_add_f32 v30, v30, v19
    v_add_f32 v29, v29, v20
    v_add_f32 v30, v30, v21
    v_add_f32 v29, v29, v22
    v_add_f32 v30, v30, v23
    v_add_f32 v29, v29, v24
    v_add_f32 v30, v30, v25
    v_add_f32 v29, v29, v30
    v_mov_b32 v56, v27
    v_mov_b32 v57, v29
    s_nop 0
    v_permlane16_swap_b32 v27, v56
    v_permlane16_swap_b32 v29, v57
    v_add_f32 v27, v27, v56
    v_add_f32 v29, v29, v57
    v_mov_b32 v56, v27
    v_mov_b32 v57, v29
    s_nop 0
    v_permlane32_swap_b32 v27, v56
    v_permlane32_swap_b32 v29, v57
    v_add_f32 v27, v27, v56
    v_add_f32 v29, v29, v57
    v_cndmask_b32_e64 v56, 0, v27, s[90:91]
    v_add_f32 v29, v29, v56
    s_lshl_b32 s7, s4, 3
    s_add_u32 s7, s7, 1600
    v_cmp_eq_u32 vcc, 16, v0
    v_lshlrev_b32 v2, 2, v0
    v_add_u32 v2, 64, v2
    v_cndmask_b32 v56, v26, v28, vcc
    v_cndmask_b32 v57, v27, v29, vcc
    v_cndmask_b32_e64 v2, v2, 0, vcc
    v_add_u32 v2, s7, v2
    v_mov_b32 v3, 1540
    v_mov_b32 v58, 1
    s_andn2_b32 s7, 0x101, s90
    s_bitset1_b32 s7, 16
    s_mov_b32 exec_lo, s7
    s_mov_b32 exec_hi, 0
    ds_write_b64 v2, v[56:57]
    s_mov_b32 exec_lo, 1
    ds_add_rtn_u32 v58, v3, v58
    s_movk_i32 exec_lo, 0xff
    v_lshlrev_b32 v2, 4, v0
    ds_read_b128 v[52:55], v2 offset:1600
    s_mul_i32 s85, s2, 3584
    s_waitcnt lgkmcnt(0)
    v_readfirstlane_b32 s7, v58
    s_nop 1
    s_cmp_lg_u32 s7, 7
    s_cbranch_scc1 L_noml
    buffer_store_dwordx4 v[52:55], v2, s[60:63], s85 offen offset:3328 sc1
L_noml:
    s_mov_b64 exec, -1
    v_cvt_pk_bf16_f32 v8, v8, v8
    v_cvt_pk_bf16_f32 v9, v9, v9
    v_cvt_pk_bf16_f32 v10, v10, v10
    v_cvt_pk_bf16_f32 v11, v11, v11
    v_cvt_pk_bf16_f32 v12, v12, v12
    v_cvt_pk_bf16_f32 v13, v13, v13
    v_cvt_pk_bf16_f32 v14, v14, v14
    v_cvt_pk_bf16_f32 v15, v15, v15
    v_cvt_pk_bf16_f32 v16, v16, v16
    v_cvt_pk_bf16_f32 v17, v17, v17
    v_cvt_pk_bf16_f32 v18, v18, v18
    v_cvt_pk_bf16_f32 v19, v19, v19
    v_cvt_pk_bf16_f32 v20, v20, v20
    v_cvt_pk_bf16_f32 v21, v21, v21
    v_cvt_pk_bf16_f32 v22, v22, v22
    v_cvt_pk_bf16_f32 v23, v23, v23
    v_cvt_pk_bf16_f32 v24, v24, v24
    v_cvt_pk_bf16_f32 v25, v25, v25
    s_mul_i32 s7, s4, 3072
    v_and_b32 v2, 15, v0
    v_lshlrev_b32 v2, 5, v2
    v_bfe_u32 v3, v0, 4, 1
    v_lshl_add_u32 v2, v3, 4, v2
    v_add_u32 v2, s7, v2
    s_cmp_ge_u32 s4, 4
    s_cbranch_scc1 L_vyoung
    v_and_b32 v48, v8, v4
    v_and_b32 v49, v8, v5
    v_and_b32 v50, v8, v6
    v_and_b32 v51, v8, v7
    v_and_b32 v52, v9, v4
    v_and_b32 v53, v9, v5
    v_and_b32 v54, v9, v6
    v_and_b32 v55, v9, v7
    v_mfma_f32_16x16x32_bf16 v[40:43], v[48:51], v[208:211], 0
    v_mfma_f32_16x16x32_bf16 v[44:47], v[48:51], v[212:215], 0
    v_mfma_f32_16x16x32_bf16 v[40:43], v[52:55], v[216:219], v[40:43]
    v_mfma_f32_16x16x32_bf16 v[44:47], v[52:55], v[220:223], v[44:47]
    v_and_b32 v48, v10, v4
    v_and_b32 v49, v10, v5
    v_and_b32 v50, v10, v6
    v_and_b32 v51, v10, v7
    v_and_b32 v52, v11, v4
    v_and_b32 v53, v11, v5
    v_and_b32 v54, v11, v6
    v_and_b32 v55, v11, v7
    v_mfma_f32_16x16x32_bf16 v[40:43], v[48:51], v[224:227], v[40:43]
    v_mfma_f32_16x16x32_bf16 v[44:47], v[48:51], v[228:231], v[44:47]
    v_mfma_f32_16x16x32_bf16 v[40:43], v[52:55], v[232:235], v[40:43]
    v_mfma_f32_16x16x32_bf16 v[44:47], v[52:55], v[236:239], v[44:47]
    v_bfe_u32 v3, v0, 5, 1
    v_lshl_add_u32 v3, v3, 10, v2
    s_nop 4
    ds_write_b128 v3, v[40:43] offset:3072
    ds_write_b128 v3, v[44:47] offset:3584
    s_waitcnt lgkmcnt(0)
    s_barrier
    v_mov_b32 v60, 1548
    ds_read_b32 v61, v60
    s_waitcnt lgkmcnt(0)
    v_readfirstlane_b32 s96, v61
    s_nop 1
    s_cmp_lt_u32 s96, 10
    s_cselect_b64 vcc, -1, 0
    s_cmp_ge_u32 s96, 22
    s_waitcnt vmcnt(6)
    s_cbranch_scc1 L_g37
    s_waitcnt vmcnt(4)
    s_cbranch_vccz L_g37
    s_waitcnt vmcnt(3)
L_g37:
    buffer_load_dwordx4 v[96:99], v1, s[48:51], s9 offen offset:0 nt
    s_waitcnt vmcnt(6)
    s_cbranch_scc1 L_g38
    s_waitcnt vmcnt(4)
    s_cbranch_vccz L_g38
    s_waitcnt vmcnt(3)
L_g38:
    buffer_load_dwordx4 v[100:103], v1, s[48:51], s9 offen offset:256 nt
    s_waitcnt vmcnt(6)
    s_cbranch_scc1 L_g39
    s_waitcnt vmcnt(4)
    s_cbranch_vccz L_g39
    s_waitcnt vmcnt(3)
L_g39:
    buffer_load_dwordx4 v[104:107], v1, s[48:51], s9 offen offset:2048 nt
    s_waitcnt vmcnt(6)
    s_cbranch_scc1 L_g40
    s_waitcnt vmcnt(4)
    s_cbranch_vccz L_g40
    s_waitcnt vmcnt(3)
L_g40:
    buffer_load_dwordx4 v[108:111], v1, s[48:51], s9 offen offset:2304 nt
    s_waitcnt vmcnt(6)
    s_cbranch_scc1 L_g41
    s_waitcnt vmcnt(4)
    s_cbranch_vccz L_g41
    s_waitcnt vmcnt(3)
L_g41:
    buffer_load_dwordx4 v[112:115], v1, s[48:51], s10 offen offset:0 nt
    s_waitcnt vmcnt(6)
    s_cbranch_scc1 L_g42
    s_waitcnt vmcnt(4)
    s_cbranch_vccz L_g42
    s_waitcnt vmcnt(3)
L_g42:
    buffer_load_dwordx4 v[116:119], v1, s[48:51], s10 offen offset:256 nt
    s_waitcnt vmcnt(6)
    s_cbranch_scc1 L_g43
    s_waitcnt vmcnt(4)
    s_cbranch_vccz L_g43
    s_waitcnt vmcnt(3)
L_g43:
    buffer_load_dwordx4 v[120:123], v1, s[48:51], s10 offen offset:2048 nt
    s_waitcnt vmcnt(6)
    s_cbranch_scc1 L_g44
    s_waitcnt vmcnt(4)
    s_cbranch_vccz L_g44
    s_waitcnt vmcnt(3)
L_g44:
    buffer_load_dwordx4 v[124:127], v1, s[48:51], s10 offen offset:2304 nt
    v_mov_b32 v60, 1548
    ds_read_b32 v61, v60
    s_waitcnt lgkmcnt(0)
    v_readfirstlane_b32 s96, v61
    s_nop 1
    s_cmp_lt_u32 s96, 10
    s_cselect_b64 vcc, -1, 0
    s_cmp_ge_u32 s96, 22
    v_and_b32 v48, v12, v4
    v_and_b32 v49, v12, v5
    v_and_b32 v50, v12, v6
    v_and_b32 v51, v12, v7
    s_waitcnt vmcnt(6)
    s_cbranch_scc1 L_g45
    s_waitcnt vmcnt(4)
    s_cbranch_vccz L_g45
    s_waitcnt vmcnt(3)
L_g45:
    buffer_load_dwordx4 v[128:131], v1, s[48:51], s11 offen offset:0 nt
    s_waitcnt vmcnt(6)
    s_cbranch_scc1 L_g46
    s_waitcnt vmcnt(4)
    s_cbranch_vccz L_g46
    s_waitcnt vmcnt(3)
L_g46:
    buffer_load_dwordx4 v[132:135], v1, s[48:51], s11 offen offset:256 nt
    v_mfma_f32_16x16x32_bf16 v[32:35], v[48:51], v[96:99], 0
    v_mfma_f32_16x16x32_bf16 v[36:39], v[48:51], v[100:103], 0
    v_and_b32 v52, v13, v4
    v_and_b32 v53, v13, v5
    v_and_b32 v54, v13, v6
    v_and_b32 v55, v13, v7
    s_waitcnt vmcnt(6)
    s_cbranch_scc1 L_g47
    s_waitcnt vmcnt(4)
    s_cbranch_vccz L_g47
    s_waitcnt vmcnt(3)
L_g47:
    buffer_load_dwordx4 v[136:139], v1, s[48:51], s11 offen offset:2048 nt
    s_waitcnt vmcnt(6)
    s_cbranch_scc1 L_g48
    s_waitcnt vmcnt(4)
    s_cbranch_vccz L_g48
    s_waitcnt vmcnt(3)
L_g48:
    buffer_load_dwordx4 v[140:143], v1, s[48:51], s11 offen offset:2304 nt
    v_mfma_f32_16x16x32_bf16 v[32:35], v[52:55], v[104:107], v[32:35]
    v_mfma_f32_16x16x32_bf16 v[36:39], v[52:55], v[108:111], v[36:39]
    v_and_b32 v48, v14, v4
    v_and_b32 v49, v14, v5
    v_and_b32 v50, v14, v6
    v_and_b32 v51, v14, v7
    s_waitcnt vmcnt(6)
    s_cbranch_scc1 L_g49
    s_waitcnt vmcnt(4)
    s_cbranch_vccz L_g49
    s_waitcnt vmcnt(3)
L_g49:
    buffer_load_dwordx4 v[144:147], v1, s[48:51], s12 offen offset:0 nt
    s_waitcnt vmcnt(6)
    s_cbranch_scc1 L_g50
    s_waitcnt vmcnt(4)
    s_cbranch_vccz L_g50
    s_waitcnt vmcnt(3)
L_g50:
    buffer_load_dwordx4 v[148:151], v1, s[48:51], s12 offen offset:256 nt
    v_mfma_f32_16x16x32_bf16 v[32:35], v[48:51], v[112:115], v[32:35]
    v_mfma_f32_16x16x32_bf16 v[36:39], v[48:51], v[116:119], v[36:39]
    v_and_b32 v52, v15, v4
    v_and_b32 v53, v15, v5
    v_and_b32 v54, v15, v6
    v_and_b32 v55, v15, v7
    s_waitcnt vmcnt(6)
    s_cbranch_scc1 L_g51
    s_waitcnt vmcnt(4)
    s_cbranch_vccz L_g51
    s_waitcnt vmcnt(3)
L_g51:
    buffer_load_dwordx4 v[152:155], v1, s[48:51], s12 offen offset:2048 nt
    s_waitcnt vmcnt(6)
    s_cbranch_scc1 L_g52
    s_waitcnt vmcnt(4)
    s_cbranch_vccz L_g52
    s_waitcnt vmcnt(3)
L_g52:
    buffer_load_dwordx4 v[156:159], v1, s[48:51], s12 offen offset:2304 nt
    v_mfma_f32_16x16x32_bf16 v[32:35], v[52:55], v[120:123], v[32:35]
    v_mfma_f32_16x16x32_bf16 v[36:39], v[52:55], v[124:127], v[36:39]
    v_and_b32 v48, v16, v4
    v_and_b32 v49, v16, v5
    v_and_b32 v50, v16, v6
    v_and_b32 v51, v16, v7
    s_waitcnt vmcnt(6)
    s_cbranch_scc1 L_g53
    s_waitcnt vmcnt(4)
    s_cbranch_vccz L_g53
    s_waitcnt vmcnt(3)
L_g53:
    buffer_load_dwordx4 v[160:163], v1, s[48:51], s13 offen offset:0 nt
    s_waitcnt vmcnt(6)
    s_cbranch_scc1 L_g54
    s_waitcnt vmcnt(4)
    s_cbranch_vccz L_g54
    s_waitcnt vmcnt(3)
L_g54:
    buffer_load_dwordx4 v[164:167], v1, s[48:51], s13 offen offset:256 nt
    v_mfma_f32_16x16x32_bf16 v[32:35], v[48:51], v[128:131], v[32:35]
    v_mfma_f32_16x16x32_bf16 v[36:39], v[48:51], v[132:135], v[36:39]
    v_and_b32 v52, v17, v4
    v_and_b32 v53, v17, v5
    v_and_b32 v54, v17, v6
    v_and_b32 v55, v17, v7
    s_waitcnt vmcnt(6)
    s_cbranch_scc1 L_g55
    s_waitcnt vmcnt(4)
    s_cbranch_vccz L_g55
    s_waitcnt vmcnt(3)
L_g55:
    buffer_load_dwordx4 v[168:171], v1, s[48:51], s13 offen offset:2048 nt
    s_waitcnt vmcnt(6)
    s_cbranch_scc1 L_g56
    s_waitcnt vmcnt(4)
    s_cbranch_vccz L_g56
    s_waitcnt vmcnt(3)
L_g56:
    buffer_load_dwordx4 v[172:175], v1, s[48:51], s13 offen offset:2304 nt
    v_mfma_f32_16x16x32_bf16 v[32:35], v[52:55], v[136:139], v[32:35]
    v_mfma_f32_16x16x32_bf16 v[36:39], v[52:55], v[140:143], v[36:39]
    v_and_b32 v48, v18, v4
    v_and_b32 v49, v18, v5
    v_and_b32 v50, v18, v6
    v_and_b32 v51, v18, v7
    s_waitcnt vmcnt(6)
    s_cbranch_scc1 L_g57
    s_waitcnt vmcnt(4)
    s_cbranch_vccz L_g57
    s_waitcnt vmcnt(3)
L_g57:
    buffer_load_dwordx4 v[176:179], v1, s[48:51], s14 offen offset:0 nt
    s_waitcnt vmcnt(6)
    s_cbranch_scc1 L_g58
    s_waitcnt vmcnt(4)
    s_cbranch_vccz L_g58
    s_waitcnt vmcnt(3)
L_g58:
    buffer_load_dwordx4 v[180:183], v1, s[48:51], s14 offen offset:256 nt
    v_mfma_f32_16x16x32_bf16 v[32:35], v[48:51], v[144:147], v[32:35]
    v_mfma_f32_16x16x32_bf16 v[36:39], v[48:51], v[148:151], v[36:39]
    v_and_b32 v52, v19, v4
    v_and_b32 v53, v19, v5
    v_and_b32 v54, v19, v6
    v_and_b32 v55, v19, v7
    s_waitcnt vmcnt(6)
    s_cbranch_scc1 L_g59
    s_waitcnt vmcnt(4)
    s_cbranch_vccz L_g59
    s_waitcnt vmcnt(3)
L_g59:
    buffer_load_dwordx4 v[184:187], v1, s[48:51], s14 offen offset:2048 nt
    s_waitcnt vmcnt(6)
    s_cbranch_scc1 L_g60
    s_waitcnt vmcnt(4)
    s_cbranch_vccz L_g60
    s_waitcnt vmcnt(3)
L_g60:
    buffer_load_dwordx4 v[188:191], v1, s[48:51], s14 offen offset:2304 nt
    v_mfma_f32_16x16x32_bf16 v[32:35], v[52:55], v[152:155], v[32:35]
    v_mfma_f32_16x16x32_bf16 v[36:39], v[52:55], v[156:159], v[36:39]
    v_and_b32 v48, v20, v4
    v_and_b32 v49, v20, v5
    v_and_b32 v50, v20, v6
    v_and_b32 v51, v20, v7
    s_waitcnt vmcnt(6)
    s_cbranch_scc1 L_g61
    s_waitcnt vmcnt(4)
    s_cbranch_vccz L_g61
    s_waitcnt vmcnt(3)
L_g61:
    buffer_load_dwordx4 v[192:195], v1, s[48:51], s15 offen offset:0 nt
    s_waitcnt vmcnt(6)
    s_cbranch_scc1 L_g62
    s_waitcnt vmcnt(4)
    s_cbranch_vccz L_g62
    s_waitcnt vmcnt(3)
L_g62:
    buffer_load_dwordx4 v[196:199], v1, s[48:51], s15 offen offset:256 nt
    v_mfma_f32_16x16x32_bf16 v[32:35], v[48:51], v[160:163], v[32:35]
    v_mfma_f32_16x16x32_bf16 v[36:39], v[48:51], v[164:167], v[36:39]
    v_and_b32 v52, v21, v4
    v_and_b32 v53, v21, v5
    v_and_b32 v54, v21, v6
    v_and_b32 v55, v21, v7
    s_waitcnt vmcnt(6)
    s_cbranch_scc1 L_g63
    s_waitcnt vmcnt(4)
    s_cbranch_vccz L_g63
    s_waitcnt vmcnt(3)
L_g63:
    buffer_load_dwordx4 v[200:203], v1, s[48:51], s15 offen offset:2048 nt
    s_waitcnt vmcnt(6)
    s_cbranch_scc1 L_g64
    s_waitcnt vmcnt(4)
    s_cbranch_vccz L_g64
    s_waitcnt vmcnt(3)
L_g64:
    buffer_load_dwordx4 v[204:207], v1, s[48:51], s15 offen offset:2304 nt
    v_mfma_f32_16x16x32_bf16 v[32:35], v[52:55], v[168:171], v[32:35]
    v_mfma_f32_16x16x32_bf16 v[36:39], v[52:55], v[172:175], v[36:39]
    s_barrier
    s_cmp_lg_u32 s4, 3
    s_cbranch_scc1 L_ps2
    s_and_b32 s7, s2, -32
    s_add_u32 s7, s7, 2
    s_mul_i32 s7, s7, 3584
    s_add_u32 s94, s40, s7
    s_addc_u32 s95, s41, 0
    s_cmp_lt_u32 s6, 8
    s_cbranch_scc1 L_mw2
    s_load_dword s93, s[94:95], 3456 glc
    s_branch L_mk2
L_mw2:
    s_mov_b32 s93, 1
    s_atomic_add s93, s[94:95], 3456 glc
L_mk2:
    s_waitcnt lgkmcnt(0)
    s_lshl2_add_u32 s93, s93, 5
    v_mov_b32 v60, 1548
    v_mov_b32 v61, s93
    ds_write_b32 v60, v61
L_ps2:
    v_and_b32 v48, v22, v4
    v_and_b32 v49, v22, v5
    v_and_b32 v50, v22, v6
    v_and_b32 v51, v22, v7
    s_waitcnt vmcnt(6)
    s_nop 0
    v_mfma_f32_16x16x32_bf16 v[32:35], v[48:51], v[176:179], v[32:35]
    v_mfma_f32_16x16x32_bf16 v[36:39], v[48:51], v[180:183], v[36:39]
    v_and_b32 v52, v23, v4
    v_and_b32 v53, v23, v5
    v_and_b32 v54, v23, v6
    v_and_b32 v55, v23, v7
    s_waitcnt vmcnt(4)
    s_nop 0
    v_mfma_f32_16x16x32_bf16 v[32:35], v[52:55], v[184:187], v[32:35]
    v_mfma_f32_16x16x32_bf16 v[36:39], v[52:55], v[188:191], v[36:39]
    v_and_b32 v48, v24, v4
    v_and_b32 v49, v24, v5
    v_and_b32 v50, v24, v6
    v_and_b32 v51, v24, v7
    s_waitcnt vmcnt(2)
    s_nop 0
    v_mfma_f32_16x16x32_bf16 v[32:35], v[48:51], v[192:195], v[32:35]
    v_mfma_f32_16x16x32_bf16 v[36:39], v[48:51], v[196:199], v[36:39]
    v_and_b32 v52, v25, v4
    v_and_b32 v53, v25, v5
    v_and_b32 v54, v25, v6
    v_and_b32 v55, v25, v7
    s_waitcnt vmcnt(0)
    s_nop 0
    v_mfma_f32_16x16x32_bf16 v[32:35], v[52:55], v[200:203], v[32:35]
    v_mfma_f32_16x16x32_bf16 v[36:39], v[52:55], v[204:207], v[36:39]
    s_nop 6
    ds_write_b128 v2, v[32:35] offset:2048
    ds_write_b128 v2, v[36:39] offset:2560
    v_mov_b32 v60, 1544
    v_mov_b32 v61, 1
    s_mov_b64 exec, 1
    ds_add_u32 v60, v61
    s_mov_b64 exec, -1
    s_cmp_eq_u32 s4, 3
    s_cbranch_scc1 L_w3
    s_and_b32 s86, s2, -16
    s_and_b32 s87, s2, -32
    s_lshl_b32 s7, s4, 5
    s_add_u32 s7, s7, 32
    s_cmp_eq_u32 s4, 0
    s_cselect_b32 s85, s86, s87
    s_cselect_b32 s7, 0, s7
    s_cselect_b32 s86, 2, 1
    s_cselect_b32 s87, 15, 31
    s_cselect_b32 s88, 3, 1
    s_mul_i32 s85, s85, 3584
    s_add_u32 s85, s85, s7
    v_lshrrev_b32 v8, s86, v0
    v_add_u32 v8, s6, v8
    v_and_b32 v8, s87, v8
    v_mul_u32_u24 v8, 3584, v8
    v_and_b32 v9, s88, v0
    v_lshl_add_u32 v8, v9, 4, v8
    v_lshlrev_b32 v2, 4, v0
    s_mov_b32 s92, 0
L_pm:
    buffer_load_dwordx4 v[64:67], v8, s[60:63], s85 offen offset:3328 sc1
    s_waitcnt vmcnt(0)
    v_max3_u32 v10, v64, v65, v66
    v_max_u32 v10, v10, v67
    v_cmp_eq_u32 vcc, -1, v10
    s_cbranch_vccz L_pmg
    s_sleep 8
    s_add_u32 s92, s92, 1
    s_cmp_lt_u32 s92, 1048576
    s_cbranch_scc1 L_pm
L_pmg:
    v_max_f32 v10, v64, v66
    s_nop 1
    v_max_f32_dpp v10, v10, v10 quad_perm:[1,0,3,2] row_mask:0xf bank_mask:0xf
    s_nop 1
    v_max_f32_dpp v10, v10, v10 quad_perm:[2,3,0,1] row_mask:0xf bank_mask:0xf
    s_nop 1
    v_max_f32_dpp v10, v10, v10 row_half_mirror row_mask:0xf bank_mask:0xf
    s_nop 1
    v_max_f32_dpp v10, v10, v10 row_ror:8 row_mask:0xf bank_mask:0xf
    v_mov_b32 v11, v10
    s_nop 1
    v_permlane16_swap_b32 v10, v11
    v_max_f32 v10, v10, v11
    v_mov_b32 v11, v10
    s_nop 1
    v_permlane32_swap_b32 v10, v11
    v_max_f32 v10, v10, v11
    v_sub_f32 v64, v64, v10
    v_sub_f32 v66, v66, v10
    v_exp_f32 v64, v64
    v_exp_f32 v66, v66
    v_mul_f32 v10, v64, v65
    v_fmac_f32 v10, v66, v67
    s_nop 1
    v_add_f32_dpp v10, v10, v10 quad_perm:[1,0,3,2] row_mask:0xf bank_mask:0xf
    s_nop 1
    v_add_f32_dpp v10, v10, v10 quad_perm:[2,3,0,1] row_mask:0xf bank_mask:0xf
    s_nop 1
    v_add_f32_dpp v10, v10, v10 row_half_mirror row_mask:0xf bank_mask:0xf
    s_nop 1
    v_add_f32_dpp v10, v10, v10 row_ror:8 row_mask:0xf bank_mask:0xf
    v_mov_b32 v11, v10
    s_nop 1
    v_permlane16_swap_b32 v10, v11
    v_add_f32 v10, v10, v11
    v_mov_b32 v11, v10
    s_nop 1
    v_permlane32_swap_b32 v10, v11
    v_add_f32 v10, v10, v11
    v_rcp_f32 v10, v10
    s_nop 0
    v_mul_f32 v64, v64, v10
    v_mul_f32 v66, v66, v10
    s_lshl_b32 s7, s4, 10
    v_add_u32 v8, s7, v2
    s_mul_i32 s85, s2, 3584
    v_readlane_b32 s16, v64, 0
    v_readlane_b32 s17, v66, 0
    v_readlane_b32 s18, v64, 1
    v_readlane_b32 s19, v66, 1
    v_readlane_b32 s20, v64, 2
    v_readlane_b32 s21, v66, 2
    v_readlane_b32 s22, v64, 3
    v_readlane_b32 s23, v66, 3
    v_mov_b32 v60, 1544
    s_mov_b32 s92, 0
L_pc:
    ds_read_b32 v61, v60
    s_waitcnt lgkmcnt(0)
    v_cmp_gt_u32 vcc, 4, v61
    s_cbranch_vccz L_pcg
    s_sleep 1
    s_add_u32 s92, s92, 1
    s_cmp_lt_u32 s92, 8388608
    s_cbranch_scc1 L_pc
L_pcg:
    ds_read_b128 v[80:83], v8 offset:2048
    ds_read_b128 v[84:87], v8 offset:5120
    ds_read_b128 v[88:91], v8 offset:8192
    ds_read_b128 v[92:95], v8 offset:11264
    s_waitcnt lgkmcnt(3)
    v_mul_f32 v12, s16, v80
    v_mul_f32 v13, s16, v81
    v_mul_f32 v14, s16, v82
    v_mul_f32 v15, s16, v83
    s_waitcnt lgkmcnt(2)
    v_fmac_f32 v12, s17, v84
    v_fmac_f32 v13, s17, v85
    v_fmac_f32 v14, s17, v86
    v_fmac_f32 v15, s17, v87
    s_waitcnt lgkmcnt(1)
    v_fmac_f32 v12, s18, v88
    v_fmac_f32 v13, s18, v89
    v_fmac_f32 v14, s18, v90
    v_fmac_f32 v15, s18, v91
    s_waitcnt lgkmcnt(0)
    v_fmac_f32 v12, s19, v92
    v_fmac_f32 v13, s19, v93
    v_fmac_f32 v14, s19, v94
    v_fmac_f32 v15, s19, v95
    s_cmp_lg_u32 s4, 0
    s_barrier
    s_cbranch_scc1 L_pub
    ds_read_b128 v[96:99], v8 offset:14336
    ds_read_b128 v[100:103], v8 offset:17408
    ds_read_b128 v[104:107], v8 offset:20480
    ds_read_b128 v[108:111], v8 offset:23552
    s_waitcnt lgkmcnt(3)
    v_fmac_f32 v12, s20, v96
    v_fmac_f32 v13, s20, v97
    v_fmac_f32 v14, s20, v98
    v_fmac_f32 v15, s20, v99
    s_waitcnt lgkmcnt(2)
    v_fmac_f32 v12, s21, v100
    v_fmac_f32 v13, s21, v101
    v_fmac_f32 v14, s21, v102
    v_fmac_f32 v15, s21, v103
    s_waitcnt lgkmcnt(1)
    v_fmac_f32 v12, s22, v104
    v_fmac_f32 v13, s22, v105
    v_fmac_f32 v14, s22, v106
    v_fmac_f32 v15, s22, v107
    s_waitcnt lgkmcnt(0)
    v_fmac_f32 v12, s23, v108
    v_fmac_f32 v13, s23, v109
    v_fmac_f32 v14, s23, v110
    v_fmac_f32 v15, s23, v111
L_pub:
    buffer_store_dwordx4 v[12:15], v8, s[60:63], s85 offen sc1
    s_barrier
    s_branch L_fin
L_w3:
    v_and_b32 v8, 7, v0
    v_lshlrev_b32 v8, 5, v8
    s_mov_b32 s92, 0
L_pa:
    global_load_dword v9, v8, s[38:39] sc1
    s_waitcnt vmcnt(0)
    v_subrev_u32 v9, 1, v9
    v_and_b32 v9, 0x8000001f, v9
    v_cmp_ne_u32 vcc, 31, v9
    s_cbranch_vccz L_pag
    s_sleep 8
    s_add_u32 s92, s92, 1
    s_cmp_lt_u32 s92, 1048576
    s_cbranch_scc1 L_pa
L_pag:
    v_mov_b32 v60, 1536
    s_mov_b32 s92, 0
L_pp:
    ds_read_b32 v61, v60
    s_waitcnt lgkmcnt(0)
    v_cmp_gt_u32 vcc, 2, v61
    s_cbranch_vccz L_ppg
    s_sleep 2
    s_add_u32 s92, s92, 1
    s_cmp_lt_u32 s92, 8388608
    s_cbranch_scc1 L_pp
L_ppg:
    s_and_b32 s7, s2, -32
    s_add_u32 s7, s7, 3
    s_mul_i32 s7, s7, 3584
    s_add_u32 s94, s40, s7
    s_addc_u32 s95, s41, 0
    s_cmp_lt_u32 s6, 8
    s_cbranch_scc1 L_mw3
    s_load_dword s93, s[94:95], 3456 glc
    s_branch L_mk3
L_mw3:
    s_mov_b32 s93, 1
    s_atomic_add s93, s[94:95], 3456 glc
L_mk3:
    s_waitcnt lgkmcnt(0)
    s_lshl2_add_u32 s93, s93, 5
    v_mov_b32 v60, 1548
    v_mov_b32 v61, s93
    ds_write_b32 v60, v61
    s_waitcnt lgkmcnt(0)
    s_barrier
    s_branch L_fin
L_vyoung:
    s_and_b32 s7, s6, 15
    s_lshl4_add_u32 s89, s5, s7
    s_mul_i32 s90, s89, 28672
    s_and_b32 s7, s4, 3
    s_lshl_b32 s7, s7, 8
    s_add_u32 s90, s90, s7
    s_add_u32 s91, s90, 7168
    s_cmp_ge_u32 s6, 16
    s_cselect_b32 s72, s24, s34
    s_cselect_b32 s73, s25, s35
    s_cselect_b32 s64, s24, s34
    s_cselect_b32 s65, s25, s35
    s_mov_b32 s74, 3670016
    s_mov_b32 s75, 0x20000
    s_mov_b32 s67, 0x20000
    s_cmp_eq_u32 s4, 7
    s_cselect_b32 s66, 0, s74
    v_bfe_u32 v30, v0, 4, 1
    v_bfe_u32 v3, v0, 5, 1
    v_lshl_add_u32 v30, v30, 1, v3
    v_bfe_u32 v3, v0, 3, 1
    v_lshl_add_u32 v30, v3, 4, v30
    v_mul_u32_u24 v30, 896, v30
    v_and_b32 v3, 7, v0
    v_lshl_add_u32 v30, v3, 4, v30
    s_barrier
    v_mov_b32 v60, 1548
    ds_read_b32 v61, v60
    s_waitcnt lgkmcnt(0)
    v_readfirstlane_b32 s96, v61
    s_nop 1
    s_cmp_lt_u32 s96, 0
    s_cselect_b64 vcc, -1, 0
    s_cmp_ge_u32 s96, 40
    s_waitcnt vmcnt(6)
    s_cbranch_scc1 L_g65
    s_waitcnt vmcnt(4)
    s_cbranch_vccz L_g65
    s_waitcnt vmcnt(3)
L_g65:
    buffer_load_dwordx4 v[64:67], v1, s[48:51], s42 offen offset:0 nt
    s_waitcnt vmcnt(6)
    s_cbranch_scc1 L_g66
    s_waitcnt vmcnt(4)
    s_cbranch_vccz L_g66
    s_waitcnt vmcnt(3)
L_g66:
    buffer_load_dwordx4 v[68:71], v1, s[48:51], s42 offen offset:256 nt
    s_waitcnt vmcnt(6)
    s_cbranch_scc1 L_g67
    s_waitcnt vmcnt(4)
    s_cbranch_vccz L_g67
    s_waitcnt vmcnt(3)
L_g67:
    buffer_load_dwordx4 v[72:75], v1, s[48:51], s42 offen offset:2048 nt
    s_waitcnt vmcnt(6)
    s_cbranch_scc1 L_g68
    s_waitcnt vmcnt(4)
    s_cbranch_vccz L_g68
    s_waitcnt vmcnt(3)
L_g68:
    buffer_load_dwordx4 v[76:79], v1, s[48:51], s42 offen offset:2304 nt
    s_waitcnt vmcnt(6)
    s_cbranch_scc1 L_g69
    s_waitcnt vmcnt(4)
    s_cbranch_vccz L_g69
    s_waitcnt vmcnt(3)
L_g69:
    buffer_load_dwordx4 v[80:83], v1, s[48:51], s8 offen offset:0 nt
    s_waitcnt vmcnt(6)
    s_cbranch_scc1 L_g70
    s_waitcnt vmcnt(4)
    s_cbranch_vccz L_g70
    s_waitcnt vmcnt(3)
L_g70:
    buffer_load_dwordx4 v[84:87], v1, s[48:51], s8 offen offset:256 nt
    s_waitcnt vmcnt(6)
    s_cbranch_scc1 L_g71
    s_waitcnt vmcnt(4)
    s_cbranch_vccz L_g71
    s_waitcnt vmcnt(3)
L_g71:
    buffer_load_dwordx4 v[88:91], v1, s[48:51], s8 offen offset:2048 nt
    s_waitcnt vmcnt(6)
    s_cbranch_scc1 L_g72
    s_waitcnt vmcnt(4)
    s_cbranch_vccz L_g72
    s_waitcnt vmcnt(3)
L_g72:
    buffer_load_dwordx4 v[92:95], v1, s[48:51], s8 offen offset:2304 nt
    v_mov_b32 v60, 1548
    ds_read_b32 v61, v60
    s_waitcnt lgkmcnt(0)
    v_readfirstlane_b32 s96, v61
    s_nop 1
    s_cmp_lt_u32 s96, 5
    s_cselect_b64 vcc, -1, 0
    s_cmp_ge_u32 s96, 24
    v_and_b32 v48, v8, v4
    v_and_b32 v49, v8, v5
    v_and_b32 v50, v8, v6
    v_and_b32 v51, v8, v7
    s_waitcnt vmcnt(6)
    s_cbranch_scc1 L_g73
    s_waitcnt vmcnt(4)
    s_cbranch_vccz L_g73
    s_waitcnt vmcnt(3)
L_g73:
    buffer_load_dwordx4 v[96:99], v1, s[48:51], s9 offen offset:0 nt
    s_waitcnt vmcnt(6)
    s_cbranch_scc1 L_g74
    s_waitcnt vmcnt(4)
    s_cbranch_vccz L_g74
    s_waitcnt vmcnt(3)
L_g74:
    buffer_load_dwordx4 v[100:103], v1, s[48:51], s9 offen offset:256 nt
    v_mfma_f32_16x16x32_bf16 v[32:35], v[48:51], v[64:67], 0
    v_mfma_f32_16x16x32_bf16 v[36:39], v[48:51], v[68:71], 0
    v_and_b32 v52, v9, v4
    v_and_b32 v53, v9, v5
    v_and_b32 v54, v9, v6
    v_and_b32 v55, v9, v7
    s_waitcnt vmcnt(6)
    s_cbranch_scc1 L_g75
    s_waitcnt vmcnt(4)
    s_cbranch_vccz L_g75
    s_waitcnt vmcnt(3)
L_g75:
    buffer_load_dwordx4 v[104:107], v1, s[48:51], s9 offen offset:2048 nt
    s_waitcnt vmcnt(6)
    s_cbranch_scc1 L_g76
    s_waitcnt vmcnt(4)
    s_cbranch_vccz L_g76
    s_waitcnt vmcnt(3)
L_g76:
    buffer_load_dwordx4 v[108:111], v1, s[48:51], s9 offen offset:2304 nt
    v_mfma_f32_16x16x32_bf16 v[32:35], v[52:55], v[72:75], v[32:35]
    v_mfma_f32_16x16x32_bf16 v[36:39], v[52:55], v[76:79], v[36:39]
    v_and_b32 v48, v10, v4
    v_and_b32 v49, v10, v5
    v_and_b32 v50, v10, v6
    v_and_b32 v51, v10, v7
    s_waitcnt vmcnt(6)
    s_cbranch_scc1 L_g77
    s_waitcnt vmcnt(4)
    s_cbranch_vccz L_g77
    s_waitcnt vmcnt(3)
L_g77:
    buffer_load_dwordx4 v[112:115], v1, s[48:51], s10 offen offset:0 nt
    s_waitcnt vmcnt(6)
    s_cbranch_scc1 L_g78
    s_waitcnt vmcnt(4)
    s_cbranch_vccz L_g78
    s_waitcnt vmcnt(3)
L_g78:
    buffer_load_dwordx4 v[116:119], v1, s[48:51], s10 offen offset:256 nt
    v_mfma_f32_16x16x32_bf16 v[32:35], v[48:51], v[80:83], v[32:35]
    v_mfma_f32_16x16x32_bf16 v[36:39], v[48:51], v[84:87], v[36:39]
    v_and_b32 v52, v11, v4
    v_and_b32 v53, v11, v5
    v_and_b32 v54, v11, v6
    v_and_b32 v55, v11, v7
    s_waitcnt vmcnt(6)
    s_cbranch_scc1 L_g79
    s_waitcnt vmcnt(4)
    s_cbranch_vccz L_g79
    s_waitcnt vmcnt(3)
L_g79:
    buffer_load_dwordx4 v[120:123], v1, s[48:51], s10 offen offset:2048 nt
    s_waitcnt vmcnt(6)
    s_cbranch_scc1 L_g80
    s_waitcnt vmcnt(4)
    s_cbranch_vccz L_g80
    s_waitcnt vmcnt(3)
L_g80:
    buffer_load_dwordx4 v[124:127], v1, s[48:51], s10 offen offset:2304 nt
    v_mfma_f32_16x16x32_bf16 v[32:35], v[52:55], v[88:91], v[32:35]
    v_mfma_f32_16x16x32_bf16 v[36:39], v[52:55], v[92:95], v[36:39]
    v_mov_b32 v60, 1536
    v_mov_b32 v61, 2
    ds_write_b32 v60, v61
    v_and_b32 v48, v12, v4
    v_and_b32 v49, v12, v5
    v_and_b32 v50, v12, v6
    v_and_b32 v51, v12, v7
    s_waitcnt vmcnt(6)
    s_cbranch_scc1 L_g81
    s_waitcnt vmcnt(4)
    s_cbranch_vccz L_g81
    s_waitcnt vmcnt(3)
L_g81:
    buffer_load_dwordx4 v[128:131], v1, s[48:51], s11 offen offset:0 nt
    s_waitcnt vmcnt(6)
    s_cbranch_scc1 L_g82
    s_waitcnt vmcnt(4)
    s_cbranch_vccz L_g82
    s_waitcnt vmcnt(3)
L_g82:
    buffer_load_dwordx4 v[132:135], v1, s[48:51], s11 offen offset:256 nt
    v_mfma_f32_16x16x32_bf16 v[32:35], v[48:51], v[96:99], v[32:35]
    v_mfma_f32_16x16x32_bf16 v[36:39], v[48:51], v[100:103], v[36:39]
    v_and_b32 v52, v13, v4
    v_and_b32 v53, v13, v5
    v_and_b32 v54, v13, v6
    v_and_b32 v55, v13, v7
    s_waitcnt vmcnt(6)
    s_cbranch_scc1 L_g83
    s_waitcnt vmcnt(4)
    s_cbranch_vccz L_g83
    s_waitcnt vmcnt(3)
L_g83:
    buffer_load_dwordx4 v[136:139], v1, s[48:51], s11 offen offset:2048 nt
    s_waitcnt vmcnt(6)
    s_cbranch_scc1 L_g84
    s_waitcnt vmcnt(4)
    s_cbranch_vccz L_g84
    s_waitcnt vmcnt(3)
L_g84:
    buffer_load_dwordx4 v[140:143], v1, s[48:51], s11 offen offset:2304 nt
    v_mfma_f32_16x16x32_bf16 v[32:35], v[52:55], v[104:107], v[32:35]
    v_mfma_f32_16x16x32_bf16 v[36:39], v[52:55], v[108:111], v[36:39]
    v_and_b32 v48, v14, v4
    v_and_b32 v49, v14, v5
    v_and_b32 v50, v14, v6
    v_and_b32 v51, v14, v7
    s_waitcnt vmcnt(6)
    s_cbranch_scc1 L_g85
    s_waitcnt vmcnt(4)
    s_cbranch_vccz L_g85
    s_waitcnt vmcnt(3)
L_g85:
    buffer_load_dwordx4 v[144:147], v1, s[48:51], s12 offen offset:0 nt
    s_waitcnt vmcnt(6)
    s_cbranch_scc1 L_g86
    s_waitcnt vmcnt(4)
    s_cbranch_vccz L_g86
    s_waitcnt vmcnt(3)
L_g86:
    buffer_load_dwordx4 v[148:151], v1, s[48:51], s12 offen offset:256 nt
    v_mfma_f32_16x16x32_bf16 v[32:35], v[48:51], v[112:115], v[32:35]
    v_mfma_f32_16x16x32_bf16 v[36:39], v[48:51], v[116:119], v[36:39]
    v_and_b32 v52, v15, v4
    v_and_b32 v53, v15, v5
    v_and_b32 v54, v15, v6
    v_and_b32 v55, v15, v7
    s_waitcnt vmcnt(6)
    s_cbranch_scc1 L_g87
    s_waitcnt vmcnt(4)
    s_cbranch_vccz L_g87
    s_waitcnt vmcnt(3)
L_g87:
    buffer_load_dwordx4 v[152:155], v1, s[48:51], s12 offen offset:2048 nt
    s_waitcnt vmcnt(6)
    s_cbranch_scc1 L_g88
    s_waitcnt vmcnt(4)
    s_cbranch_vccz L_g88
    s_waitcnt vmcnt(3)
L_g88:
    buffer_load_dwordx4 v[156:159], v1, s[48:51], s12 offen offset:2304 nt
    v_mfma_f32_16x16x32_bf16 v[32:35], v[52:55], v[120:123], v[32:35]
    v_mfma_f32_16x16x32_bf16 v[36:39], v[52:55], v[124:127], v[36:39]
    v_mov_b32 v60, 1548
    ds_read_b32 v61, v60
    s_waitcnt lgkmcnt(0)
    v_readfirstlane_b32 s96, v61
    s_nop 1
    s_cmp_lt_u32 s96, 5
    s_cselect_b64 vcc, -1, 0
    s_cmp_ge_u32 s96, 24
    v_and_b32 v48, v16, v4
    v_and_b32 v49, v16, v5
    v_and_b32 v50, v16, v6
    v_and_b32 v51, v16, v7
    s_waitcnt vmcnt(6)
    s_cbranch_scc1 L_g89
    s_waitcnt vmcnt(4)
    s_cbranch_vccz L_g89
    s_waitcnt vmcnt(3)
L_g89:
    buffer_load_dwordx4 v[160:163], v1, s[48:51], s13 offen offset:0 nt
    s_waitcnt vmcnt(6)
    s_cbranch_scc1 L_g90
    s_waitcnt vmcnt(4)
    s_cbranch_vccz L_g90
    s_waitcnt vmcnt(3)
L_g90:
    buffer_load_dwordx4 v[164:167], v1, s[48:51], s13 offen offset:256 nt
    v_mfma_f32_16x16x32_bf16 v[32:35], v[48:51], v[128:131], v[32:35]
    v_mfma_f32_16x16x32_bf16 v[36:39], v[48:51], v[132:135], v[36:39]
    v_and_b32 v52, v17, v4
    v_and_b32 v53, v17, v5
    v_and_b32 v54, v17, v6
    v_and_b32 v55, v17, v7
    s_waitcnt vmcnt(6)
    s_cbranch_scc1 L_g91
    s_waitcnt vmcnt(4)
    s_cbranch_vccz L_g91
    s_waitcnt vmcnt(3)
L_g91:
    buffer_load_dwordx4 v[168:171], v1, s[48:51], s13 offen offset:2048 nt
    s_waitcnt vmcnt(6)
    s_cbranch_scc1 L_g92
    s_waitcnt vmcnt(4)
    s_cbranch_vccz L_g92
    s_waitcnt vmcnt(3)
L_g92:
    buffer_load_dwordx4 v[172:175], v1, s[48:51], s13 offen offset:2304 nt
    v_mfma_f32_16x16x32_bf16 v[32:35], v[52:55], v[136:139], v[32:35]
    v_mfma_f32_16x16x32_bf16 v[36:39], v[52:55], v[140:143], v[36:39]
    v_and_b32 v48, v18, v4
    v_and_b32 v49, v18, v5
    v_and_b32 v50, v18, v6
    v_and_b32 v51, v18, v7
    s_waitcnt vmcnt(6)
    s_cbranch_scc1 L_g93
    s_waitcnt vmcnt(4)
    s_cbranch_vccz L_g93
    s_waitcnt vmcnt(3)
L_g93:
    buffer_load_dwordx4 v[176:179], v1, s[48:51], s14 offen offset:0 nt
    s_waitcnt vmcnt(6)
    s_cbranch_scc1 L_g94
    s_waitcnt vmcnt(4)
    s_cbranch_vccz L_g94
    s_waitcnt vmcnt(3)
L_g94:
    buffer_load_dwordx4 v[180:183], v1, s[48:51], s14 offen offset:256 nt
    v_mfma_f32_16x16x32_bf16 v[32:35], v[48:51], v[144:147], v[32:35]
    v_mfma_f32_16x16x32_bf16 v[36:39], v[48:51], v[148:151], v[36:39]
    v_and_b32 v52, v19, v4
    v_and_b32 v53, v19, v5
    v_and_b32 v54, v19, v6
    v_and_b32 v55, v19, v7
    s_waitcnt vmcnt(6)
    s_cbranch_scc1 L_g95
    s_waitcnt vmcnt(4)
    s_cbranch_vccz L_g95
    s_waitcnt vmcnt(3)
L_g95:
    buffer_load_dwordx4 v[184:187], v1, s[48:51], s14 offen offset:2048 nt
    s_waitcnt vmcnt(6)
    s_cbranch_scc1 L_g96
    s_waitcnt vmcnt(4)
    s_cbranch_vccz L_g96
    s_waitcnt vmcnt(3)
L_g96:
    buffer_load_dwordx4 v[188:191], v1, s[48:51], s14 offen offset:2304 nt
    v_mfma_f32_16x16x32_bf16 v[32:35], v[52:55], v[152:155], v[32:35]
    v_mfma_f32_16x16x32_bf16 v[36:39], v[52:55], v[156:159], v[36:39]
    v_and_b32 v48, v20, v4
    v_and_b32 v49, v20, v5
    v_and_b32 v50, v20, v6
    v_and_b32 v51, v20, v7
    s_waitcnt vmcnt(6)
    s_cbranch_scc1 L_g97
    s_waitcnt vmcnt(4)
    s_cbranch_vccz L_g97
    s_waitcnt vmcnt(3)
L_g97:
    buffer_load_dwordx4 v[192:195], v1, s[48:51], s15 offen offset:0 nt
    s_waitcnt vmcnt(6)
    s_cbranch_scc1 L_g98
    s_waitcnt vmcnt(4)
    s_cbranch_vccz L_g98
    s_waitcnt vmcnt(3)
L_g98:
    buffer_load_dwordx4 v[196:199], v1, s[48:51], s15 offen offset:256 nt
    v_mfma_f32_16x16x32_bf16 v[32:35], v[48:51], v[160:163], v[32:35]
    v_mfma_f32_16x16x32_bf16 v[36:39], v[48:51], v[164:167], v[36:39]
    v_and_b32 v52, v21, v4
    v_and_b32 v53, v21, v5
    v_and_b32 v54, v21, v6
    v_and_b32 v55, v21, v7
    s_waitcnt vmcnt(6)
    s_cbranch_scc1 L_g99
    s_waitcnt vmcnt(4)
    s_cbranch_vccz L_g99
    s_waitcnt vmcnt(3)
L_g99:
    buffer_load_dwordx4 v[200:203], v1, s[48:51], s15 offen offset:2048 nt
    s_waitcnt vmcnt(6)
    s_cbranch_scc1 L_g100
    s_waitcnt vmcnt(4)
    s_cbranch_vccz L_g100
    s_waitcnt vmcnt(3)
L_g100:
    buffer_load_dwordx4 v[204:207], v1, s[48:51], s15 offen offset:2304 nt
    v_mfma_f32_16x16x32_bf16 v[32:35], v[52:55], v[168:171], v[32:35]
    v_mfma_f32_16x16x32_bf16 v[36:39], v[52:55], v[172:175], v[36:39]
    v_and_b32 v48, v22, v4
    v_and_b32 v49, v22, v5
    v_and_b32 v50, v22, v6
    v_and_b32 v51, v22, v7
    s_waitcnt vmcnt(6)
    s_nop 0
    v_mfma_f32_16x16x32_bf16 v[32:35], v[48:51], v[176:179], v[32:35]
    v_mfma_f32_16x16x32_bf16 v[36:39], v[48:51], v[180:183], v[36:39]
    v_and_b32 v52, v23, v4
    v_and_b32 v53, v23, v5
    v_and_b32 v54, v23, v6
    v_and_b32 v55, v23, v7
    s_waitcnt vmcnt(4)
    s_nop 0
    v_mfma_f32_16x16x32_bf16 v[32:35], v[52:55], v[184:187], v[32:35]
    v_mfma_f32_16x16x32_bf16 v[36:39], v[52:55], v[188:191], v[36:39]
    v_and_b32 v48, v24, v4
    v_and_b32 v49, v24, v5
    v_and_b32 v50, v24, v6
    v_and_b32 v51, v24, v7
    s_waitcnt vmcnt(2)
    s_nop 0
    v_mfma_f32_16x16x32_bf16 v[32:35], v[48:51], v[192:195], v[32:35]
    v_mfma_f32_16x16x32_bf16 v[36:39], v[48:51], v[196:199], v[36:39]
    buffer_load_dwordx4 v[224:227], v30, s[72:75], s90 offen offset:0 nt
    buffer_load_dwordx4 v[228:231], v30, s[64:67], s90 offen offset:128 nt
    buffer_load_dwordx4 v[232:235], v30, s[72:75], s90 offen offset:3584 nt
    buffer_load_dwordx4 v[236:239], v30, s[64:67], s90 offen offset:3712 nt
    v_and_b32 v52, v25, v4
    v_and_b32 v53, v25, v5
    v_and_b32 v54, v25, v6
    v_and_b32 v55, v25, v7
    s_waitcnt vmcnt(4)
    s_nop 0
    v_mfma_f32_16x16x32_bf16 v[32:35], v[52:55], v[200:203], v[32:35]
    v_mfma_f32_16x16x32_bf16 v[36:39], v[52:55], v[204:207], v[36:39]
    s_nop 6
    ds_write_b128 v2, v[32:35] offset:2048
    ds_write_b128 v2, v[36:39] offset:2560
    s_waitcnt lgkmcnt(0)
    s_barrier
    s_lshr_b32 s7, s6, 3
    s_cmp_ge_u32 s6, 16
    s_cselect_b64 s[20:21], -1, 0
    s_cselect_b64 s[22:23], -1, 0
    s_cselect_b32 s88, 0, s7
    s_cselect_b32 s86, s7, 1
    s_cselect_b32 s85, 0, 128
    s_sub_u32 s86, s86, 1
    s_lshl1_add_u32 s88, s5, s88
    s_mul_i32 s8, s88, 57344
    s_lshl_b32 s7, s86, 10
    s_add_u32 s8, s8, s7
    s_and_b32 s7, s6, 7
    s_lshl_b32 s7, s7, 7
    s_add_u32 s8, s8, s7
    s_add_u32 s9, s8, 28672
    s_add_u32 s10, s8, 57344
    s_add_u32 s11, s8, 86016
    v_lshrrev_b32 v2, 3, v0
    v_and_b32 v3, 7, v0
    v_lshlrev_b32 v3, 4, v3
    v_mul_u32_u24 v8, 3584, v2
    v_add_u32 v8, v8, v3
    s_mov_b64 s[16:17], -1
    s_mov_b64 s[18:19], -1
    s_add_u32 s85, s85, s89
    s_mul_i32 s85, s85, 1792
    s_and_b32 s7, s4, 3
    s_lshl_b32 s7, s7, 9
    s_add_u32 s85, s85, s7
    s_add_u32 s85, s85, 917504
    s_cmp_eq_u32 s4, 7
    s_cselect_b32 s87, 0, 0x00ff00ff
    v_lshrrev_b32 v2, 4, v0
    v_lshl_add_u32 v2, v2, 7, v3
    v_mov_b32 v72, 0
    v_mov_b32 v73, 0
    v_mov_b32 v74, 0
    v_mov_b32 v75, 0
    v_mov_b32 v76, 0
    v_mov_b32 v77, 0
    v_mov_b32 v78, 0
    v_mov_b32 v79, 0
    s_barrier
    buffer_load_dwordx4 v[240:243], v30, s[72:75], s91 offen offset:0 nt
    buffer_load_dwordx4 v[244:247], v30, s[64:67], s91 offen offset:128 nt
    buffer_load_dwordx4 v[248:251], v30, s[72:75], s91 offen offset:3584 nt
    buffer_load_dwordx4 v[252:255], v30, s[64:67], s91 offen offset:3712 nt
    s_waitcnt vmcnt(2)
    s_mov_b32 s92, 0
L_p1:
    s_mov_b64 exec, s[16:17]
    s_cbranch_execz L_p1s0
    buffer_load_dwordx4 v[64:67], v8, s[60:63], s8 offen sc1
L_p1s0:
    s_mov_b64 exec, s[18:19]
    s_cbranch_execz L_p1s1
    buffer_load_dwordx4 v[68:71], v8, s[60:63], s9 offen sc1
L_p1s1:
    s_mov_b64 exec, s[20:21]
    s_cbranch_execz L_p1s2
    buffer_load_dwordx4 v[72:75], v8, s[60:63], s10 offen sc1
L_p1s2:
    s_mov_b64 exec, s[22:23]
    s_cbranch_execz L_p1s3
    buffer_load_dwordx4 v[76:79], v8, s[60:63], s11 offen sc1
L_p1s3:
    s_mov_b64 exec, -1
    s_waitcnt vmcnt(0)
    v_pk_add_f32 v[40:41], v[64:65], v[68:69]
    v_pk_add_f32 v[42:43], v[66:67], v[70:71]
    v_pk_add_f32 v[44:45], v[72:73], v[76:77]
    v_pk_add_f32 v[46:47], v[74:75], v[78:79]
    v_pk_add_f32 v[40:41], v[40:41], v[44:45]
    v_pk_add_f32 v[42:43], v[42:43], v[46:47]
    v_pk_add_f32 v[44:45], v[40:41], v[42:43]
    v_cmp_u_f32 vcc, v44, v45
    s_cbranch_vccz L_p1g
    v_max3_u32 v16, v64, v65, v66
    v_max3_u32 v17, v68, v69, v70
    v_max3_u32 v18, v72, v73, v74
    v_max3_u32 v19, v76, v77, v78
    v_max_u32 v16, v16, v67
    v_max_u32 v17, v17, v71
    v_max_u32 v18, v18, v75
    v_max_u32 v19, v19, v79
    v_cmp_eq_u32 s[16:17], -1, v16
    v_cmp_eq_u32 s[18:19], -1, v17
    v_cmp_eq_u32 s[20:21], -1, v18
    v_cmp_eq_u32 s[22:23], -1, v19
    s_or_b64 s[24:25], s[16:17], s[18:19]
    s_or_b64 s[26:27], s[20:21], s[22:23]
    s_or_b64 s[24:25], s[24:25], s[26:27]
    s_cbranch_scc0 L_p1g
    s_add_u32 s92, s92, 1
    s_cmp_lt_u32 s92, 1048576
    s_cbranch_scc1 L_p1
L_p1g:
    v_permlane32_swap_b32 v40, v41
    v_permlane32_swap_b32 v42, v43
    v_add_f32 v40, v40, v41
    v_add_f32 v42, v42, v43
    s_nop 1
    v_permlane16_swap_b32 v40, v42
    v_add_f32 v40, v40, v42
    s_nop 1
    v_add_f32_dpp v40, v40, v40 row_ror:8 row_mask:0xf bank_mask:0xf
    v_cvt_pk_bf16_f32 v20, v40, v40
    s_nop 1
    v_mov_b32_dpp v24, v20 row_newbcast:0 row_mask:0xf bank_mask:0x3
    v_mov_b32_dpp v25, v20 row_newbcast:1 row_mask:0xf bank_mask:0x3
    v_mov_b32_dpp v26, v20 row_newbcast:2 row_mask:0xf bank_mask:0x3
    v_mov_b32_dpp v27, v20 row_newbcast:3 row_mask:0xf bank_mask:0x3
    v_mov_b32_dpp v24, v20 row_newbcast:4 row_mask:0xf bank_mask:0xc
    v_mov_b32_dpp v25, v20 row_newbcast:5 row_mask:0xf bank_mask:0xc
    v_mov_b32_dpp v26, v20 row_newbcast:6 row_mask:0xf bank_mask:0xc
    v_mov_b32_dpp v27, v20 row_newbcast:7 row_mask:0xf bank_mask:0xc
    v_and_b32 v88, v24, v4
    v_and_b32 v89, v24, v5
    v_and_b32 v90, v24, v6
    v_and_b32 v91, v24, v7
    v_and_b32 v92, v25, v4
    v_and_b32 v93, v25, v5
    v_and_b32 v94, v25, v6
    v_and_b32 v95, v25, v7
    v_mfma_f32_16x16x32_bf16 v[32:35], v[88:91], v[224:227], 0
    v_mfma_f32_16x16x32_bf16 v[36:39], v[88:91], v[228:231], 0
    v_and_b32 v96, v26, v4
    v_and_b32 v97, v26, v5
    v_and_b32 v98, v26, v6
    v_and_b32 v99, v26, v7
    v_mfma_f32_16x16x32_bf16 v[32:35], v[92:95], v[232:235], v[32:35]
    v_mfma_f32_16x16x32_bf16 v[36:39], v[92:95], v[236:239], v[36:39]
    v_and_b32 v100, v27, v4
    v_and_b32 v101, v27, v5
    v_and_b32 v102, v27, v6
    v_and_b32 v103, v27, v7
    v_mfma_f32_16x16x32_bf16 v[32:35], v[96:99], v[240:243], v[32:35]
    v_mfma_f32_16x16x32_bf16 v[36:39], v[96:99], v[244:247], v[36:39]
    v_mfma_f32_16x16x32_bf16 v[32:35], v[100:103], v[248:251], v[32:35]
    v_mfma_f32_16x16x32_bf16 v[36:39], v[100:103], v[252:255], v[36:39]
    s_nop 7
    v_permlane32_swap_b32 v32, v36
    v_permlane32_swap_b32 v33, v37
    v_permlane32_swap_b32 v34, v38
    v_permlane32_swap_b32 v35, v39
    v_add_f32_dpp v32, v36, v32 row_ror:8 row_mask:0xf bank_mask:0xf
    v_add_f32_dpp v33, v37, v33 row_ror:8 row_mask:0xf bank_mask:0xf
    v_add_f32_dpp v34, v38, v34 row_ror:8 row_mask:0xf bank_mask:0xf
    v_add_f32_dpp v35, v39, v35 row_ror:8 row_mask:0xf bank_mask:0xf
    s_mov_b32 exec_lo, 0x00ff00ff
    s_mov_b32 exec_hi, s87
    buffer_store_dwordx4 v[32:35], v2, s[60:63], s85 offen sc1
    s_mov_b64 exec, -1
    s_mul_i32 s7, s2, 7282
    s_lshr_b32 s12, s7, 16
    s_mul_i32 s7, s12, 9
    s_cmp_lg_u32 s7, s2
    s_cbranch_scc1 L_fin
    s_cmp_ge_u32 s12, 28
    s_cbranch_scc1 L_fin
    s_cmp_ge_u32 s12, 14
    s_cselect_b32 s85, 229376, 0
    s_cselect_b32 s13, 14, 0
    s_cselect_b32 s86, 896, 0
    s_sub_u32 s13, s12, s13
    s_lshl_b32 s7, s13, 7
    s_add_u32 s85, s85, s7
    s_and_b32 s7, s4, 3
    s_mul_i32 s7, s7, 57344
    s_add_u32 s85, s85, s7
    s_add_u32 s8, s85, 917504
    s_add_u32 s9, s8, 14336
    s_add_u32 s10, s9, 14336
    s_add_u32 s11, s10, 14336
    v_lshrrev_b32 v8, 3, v0
    v_mul_u32_u24 v8, 1792, v8
    v_add_u32 v8, v8, v3
    s_lshr_b32 s7, s13, 1
    s_lshl_b32 s7, s7, 7
    s_add_u32 s86, s86, s7
    s_and_b32 s7, s13, 1
    s_lshl3_add_u32 s86, s7, s86
    v_bfe_u32 v2, v0, 4, 1
    v_bfe_u32 v9, v0, 5, 1
    v_lshl_add_u32 v2, v2, 1, v9
    v_lshl_add_u32 v2, v2, 1, v3
    s_and_b32 s7, s4, 3
    s_lshl_b32 s7, s7, 8
    v_lshlrev_b32 v9, 2, v0
    v_add_u32 v10, s7, v9
    s_mov_b32 s76, s36
    s_mov_b32 s77, s37
    s_mov_b32 s78, 1792
    s_mov_b32 s79, 0x20000
    s_mov_b64 s[16:17], -1
    s_mov_b64 s[18:19], -1
    s_mov_b64 s[20:21], -1
    s_mov_b64 s[22:23], -1
    s_waitcnt vmcnt(0)
    s_barrier
    s_mov_b32 s92, 0
L_p2:
    s_mov_b64 exec, s[16:17]
    s_cbranch_execz L_p2s0
    buffer_load_dwordx4 v[64:67], v8, s[60:63], s8 offen sc1
L_p2s0:
    s_mov_b64 exec, s[18:19]
    s_cbranch_execz L_p2s1
    buffer_load_dwordx4 v[68:71], v8, s[60:63], s9 offen sc1
L_p2s1:
    s_mov_b64 exec, s[20:21]
    s_cbranch_execz L_p2s2
    buffer_load_dwordx4 v[72:75], v8, s[60:63], s10 offen sc1
L_p2s2:
    s_mov_b64 exec, s[22:23]
    s_cbranch_execz L_p2s3
    buffer_load_dwordx4 v[76:79], v8, s[60:63], s11 offen sc1
L_p2s3:
    s_mov_b64 exec, -1
    s_waitcnt vmcnt(0)
    v_pk_add_f32 v[40:41], v[64:65], v[68:69]
    v_pk_add_f32 v[42:43], v[66:67], v[70:71]
    v_pk_add_f32 v[44:45], v[72:73], v[76:77]
    v_pk_add_f32 v[46:47], v[74:75], v[78:79]
    v_pk_add_f32 v[40:41], v[40:41], v[44:45]
    v_pk_add_f32 v[42:43], v[42:43], v[46:47]
    v_pk_add_f32 v[44:45], v[40:41], v[42:43]
    v_cmp_u_f32 vcc, v44, v45
    s_cbranch_vccz L_p2g
    v_max3_u32 v16, v64, v65, v66
    v_max3_u32 v17, v68, v69, v70
    v_max3_u32 v18, v72, v73, v74
    v_max3_u32 v19, v76, v77, v78
    v_max_u32 v16, v16, v67
    v_max_u32 v17, v17, v71
    v_max_u32 v18, v18, v75
    v_max_u32 v19, v19, v79
    v_cmp_eq_u32 s[16:17], -1, v16
    v_cmp_eq_u32 s[18:19], -1, v17
    v_cmp_eq_u32 s[20:21], -1, v18
    v_cmp_eq_u32 s[22:23], -1, v19
    s_or_b64 s[24:25], s[16:17], s[18:19]
    s_or_b64 s[26:27], s[20:21], s[22:23]
    s_or_b64 s[24:25], s[24:25], s[26:27]
    s_cbranch_scc0 L_p2g
    s_add_u32 s92, s92, 1
    s_cmp_lt_u32 s92, 1048576
    s_cbranch_scc1 L_p2
L_p2g:
    v_permlane32_swap_b32 v40, v41
    v_permlane32_swap_b32 v42, v43
    v_add_f32 v40, v40, v41
    v_add_f32 v42, v42, v43
    s_nop 1
    v_permlane16_swap_b32 v40, v42
    v_add_f32 v40, v40, v42
    s_nop 1
    v_add_f32_dpp v40, v40, v40 row_ror:8 row_mask:0xf bank_mask:0xf
    ds_write_b32 v10, v40
    s_waitcnt lgkmcnt(0)
    s_barrier
    s_cmp_lg_u32 s4, 4
    s_cbranch_scc1 L_fin
    ds_read2st64_b32 v[42:43], v9 offset0:1 offset1:2
    ds_read_b32 v44, v9 offset:768
    s_waitcnt lgkmcnt(0)
    v_add_f32 v40, v40, v42
    v_add_f32 v43, v43, v44
    v_add_f32 v40, v40, v43
    v_cvt_pk_bf16_f32 v40, v40, v40
    s_mov_b32 exec_lo, 0x00ff00ff
    s_mov_b32 exec_hi, 0x00ff00ff
    buffer_store_short v40, v2, s[76:79], s86 offen
L_fin:
L_end:
    s_endpgm
    .p2align 12
L_svcA:
    s_load_dwordx8 s[32:39], s[0:1], 64
    s_load_dwordx2 s[40:41], s[0:1], 96
    s_lshr_b32 s4, s4, 6
    s_and_b32 s6, s2, 31
    s_mov_b32 s62, 1376256
    s_mov_b32 s63, 0x20000
    s_setprio 3
    s_mov_b32 s66, 3670016
    s_mov_b32 s67, 0x20000
    s_mov_b32 s70, 896
    s_mov_b32 s71, 0x20000
    s_and_b32 s85, s6, 1
    s_mul_i32 s86, s85, 448
    s_mul_i32 s85, s85, 1835008
    s_bfe_u32 s7, s6, 0x30001
    s_lshl_b32 s7, s7, 7
    s_add_u32 s85, s85, s7
    s_lshl_b32 s7, s5, 10
    s_add_u32 s85, s85, s7
    v_lshrrev_b32 v2, 3, v0
    v_mul_u32_u24 v3, 56, v2
    v_mul_u32_u24 v2, 229376, v2
    v_and_b32 v8, 7, v0
    v_lshl_add_u32 v2, v8, 4, v2
    v_mov_b32 v28, 1536
    v_mov_b32 v24, 0
    v_mov_b32 v25, 0
    v_mov_b32 v26, 0
    v_mov_b32 v27, 10
    ds_write_b128 v28, v[24:27]
    s_cmp_ge_u32 s6, 16
    s_waitcnt lgkmcnt(0)
    s_cselect_b32 s64, s22, s32
    s_cselect_b32 s65, s23, s33
    s_cselect_b32 s68, s16, s26
    s_cselect_b32 s69, s17, s27
    buffer_load_dwordx4 v[64:67], v2, s[64:67], s85 offen nt
    s_addk_i32 s85, 8192
    buffer_load_dwordx4 v[8:11], v3, s[68:71], s86 offen
    buffer_load_dwordx4 v[12:15], v3, s[68:71], s86 offen offset:16
    buffer_load_dwordx4 v[16:19], v3, s[68:71], s86 offen offset:32
    buffer_load_dwordx2 v[20:21], v3, s[68:71], s86 offen offset:48
    buffer_load_dwordx4 v[68:71], v2, s[64:67], s85 offen nt
    s_addk_i32 s85, 8192
    buffer_load_dwordx4 v[72:75], v2, s[64:67], s85 offen nt
    s_addk_i32 s85, 8192
    buffer_load_dwordx4 v[76:79], v2, s[64:67], s85 offen nt
    s_addk_i32 s85, 8192
    buffer_load_dwordx4 v[80:83], v2, s[64:67], s85 offen nt
    s_addk_i32 s85, 8192
    buffer_load_dwordx4 v[84:87], v2, s[64:67], s85 offen nt
    s_addk_i32 s85, 8192
    buffer_load_dwordx4 v[88:91], v2, s[64:67], s85 offen nt
    s_addk_i32 s85, 8192
    buffer_load_dwordx4 v[92:95], v2, s[64:67], s85 offen nt
    s_addk_i32 s85, 8192
    buffer_load_dwordx4 v[96:99], v2, s[64:67], s85 offen nt
    s_addk_i32 s85, 8192
    buffer_load_dwordx4 v[100:103], v2, s[64:67], s85 offen nt
    s_addk_i32 s85, 8192
    buffer_load_dwordx4 v[104:107], v2, s[64:67], s85 offen nt
    s_addk_i32 s85, 8192
    buffer_load_dwordx4 v[108:111], v2, s[64:67], s85 offen nt
    s_addk_i32 s85, 8192
    buffer_load_dwordx4 v[112:115], v2, s[64:67], s85 offen nt
    s_addk_i32 s85, 8192
    buffer_load_dwordx4 v[116:119], v2, s[64:67], s85 offen nt
    s_addk_i32 s85, 8192
    buffer_load_dwordx4 v[120:123], v2, s[64:67], s85 offen nt
    s_addk_i32 s85, 8192
    buffer_load_dwordx4 v[124:127], v2, s[64:67], s85 offen nt
    s_addk_i32 s85, 8192
    buffer_load_dwordx4 v[128:131], v2, s[64:67], s85 offen nt
    s_addk_i32 s85, 8192
    buffer_load_dwordx4 v[132:135], v2, s[64:67], s85 offen nt
    s_addk_i32 s85, 8192
    s_waitcnt vmcnt(21)
    buffer_load_dwordx4 v[136:139], v2, s[64:67], s85 offen nt
    s_addk_i32 s85, 8192
    s_waitcnt vmcnt(21)
    buffer_load_dwordx4 v[140:143], v2, s[64:67], s85 offen nt
    s_addk_i32 s85, 8192
    s_waitcnt vmcnt(21)
    buffer_load_dwordx4 v[144:147], v2, s[64:67], s85 offen nt
    s_addk_i32 s85, 8192
    s_waitcnt vmcnt(21)
    buffer_load_dwordx4 v[148:151], v2, s[64:67], s85 offen nt
    s_addk_i32 s85, 8192
    s_waitcnt vmcnt(21)
    buffer_load_dwordx4 v[152:155], v2, s[64:67], s85 offen nt
    s_addk_i32 s85, 8192
    s_waitcnt vmcnt(21)
    buffer_load_dwordx4 v[156:159], v2, s[64:67], s85 offen nt
    s_addk_i32 s85, 8192
    s_waitcnt vmcnt(21)
    buffer_load_dwordx4 v[160:163], v2, s[64:67], s85 offen nt
    s_addk_i32 s85, 8192
    s_waitcnt vmcnt(21)
    buffer_load_dwordx4 v[164:167], v2, s[64:67], s85 offen nt
    s_addk_i32 s85, 8192
    s_waitcnt vmcnt(21)
    buffer_load_dwordx4 v[168:171], v2, s[64:67], s85 offen nt
    s_addk_i32 s85, 8192
    s_waitcnt vmcnt(21)
    buffer_load_dwordx4 v[172:175], v2, s[64:67], s85 offen nt
    s_barrier
    v_and_b32 v2, 1, v0
    v_lshlrev_b32 v2, 4, v2
    v_mov_b32 v3, 0xffff
    v_lshlrev_b32 v2, v2, v3
    v_bfe_u32 v3, v0, 1, 2
    v_cmp_eq_u32 vcc, 0, v3
    s_nop 1
    v_cndmask_b32 v4, 0, v2, vcc
    v_cmp_eq_u32 vcc, 1, v3
    s_nop 1
    v_cndmask_b32 v5, 0, v2, vcc
    v_cmp_eq_u32 vcc, 2, v3
    s_nop 1
    v_cndmask_b32 v6, 0, v2, vcc
    v_cmp_eq_u32 vcc, 3, v3
    s_nop 1
    v_cndmask_b32 v7, 0, v2, vcc
    s_mov_b32 s60, s40
    s_mov_b32 s61, s41
    s_mov_b32 s85, 0x01000100
    s_mov_b32 s86, 0x03020302
    s_waitcnt vmcnt(27)
    v_perm_b32 v30, v8, v8, s85
    v_and_b32 v48, v30, v4
    v_and_b32 v49, v30, v5
    v_and_b32 v50, v30, v6
    v_and_b32 v51, v30, v7
    s_waitcnt vmcnt(27)
    s_nop 0
    v_mfma_f32_16x16x32_bf16 v[32:35], v[48:51], v[64:67], 0
    v_perm_b32 v30, v8, v8, s86
    v_and_b32 v52, v30, v4
    v_and_b32 v53, v30, v5
    v_and_b32 v54, v30, v6
    v_and_b32 v55, v30, v7
    s_waitcnt vmcnt(26)
    s_nop 0
    v_mfma_f32_16x16x32_bf16 v[32:35], v[52:55], v[68:71], v[32:35]
    v_perm_b32 v30, v9, v9, s85
    v_and_b32 v48, v30, v4
    v_and_b32 v49, v30, v5
    v_and_b32 v50, v30, v6
    v_and_b32 v51, v30, v7
    s_waitcnt vmcnt(25)
    s_nop 0
    v_mfma_f32_16x16x32_bf16 v[32:35], v[48:51], v[72:75], v[32:35]
    v_perm_b32 v30, v9, v9, s86
    v_and_b32 v52, v30, v4
    v_and_b32 v53, v30, v5
    v_and_b32 v54, v30, v6
    v_and_b32 v55, v30, v7
    s_waitcnt vmcnt(24)
    s_nop 0
    v_mfma_f32_16x16x32_bf16 v[32:35], v[52:55], v[76:79], v[32:35]
    v_perm_b32 v30, v10, v10, s85
    v_and_b32 v48, v30, v4
    v_and_b32 v49, v30, v5
    v_and_b32 v50, v30, v6
    v_and_b32 v51, v30, v7
    s_waitcnt vmcnt(23)
    s_nop 0
    v_mfma_f32_16x16x32_bf16 v[32:35], v[48:51], v[80:83], v[32:35]
    v_perm_b32 v30, v10, v10, s86
    v_and_b32 v52, v30, v4
    v_and_b32 v53, v30, v5
    v_and_b32 v54, v30, v6
    v_and_b32 v55, v30, v7
    s_waitcnt vmcnt(22)
    s_nop 0
    v_mfma_f32_16x16x32_bf16 v[32:35], v[52:55], v[84:87], v[32:35]
    v_perm_b32 v30, v11, v11, s85
    v_and_b32 v48, v30, v4
    v_and_b32 v49, v30, v5
    v_and_b32 v50, v30, v6
    v_and_b32 v51, v30, v7
    s_waitcnt vmcnt(21)
    s_nop 0
    v_mfma_f32_16x16x32_bf16 v[32:35], v[48:51], v[88:91], v[32:35]
    v_perm_b32 v30, v11, v11, s86
    v_and_b32 v52, v30, v4
    v_and_b32 v53, v30, v5
    v_and_b32 v54, v30, v6
    v_and_b32 v55, v30, v7
    s_waitcnt vmcnt(20)
    s_nop 0
    v_mfma_f32_16x16x32_bf16 v[32:35], v[52:55], v[92:95], v[32:35]
    v_perm_b32 v30, v12, v12, s85
    v_and_b32 v48, v30, v4
    v_and_b32 v49, v30, v5
    v_and_b32 v50, v30, v6
    v_and_b32 v51, v30, v7
    s_waitcnt vmcnt(19)
    s_nop 0
    v_mfma_f32_16x16x32_bf16 v[32:35], v[48:51], v[96:99], v[32:35]
    v_perm_b32 v30, v12, v12, s86
    v_and_b32 v52, v30, v4
    v_and_b32 v53, v30, v5
    v_and_b32 v54, v30, v6
    v_and_b32 v55, v30, v7
    s_waitcnt vmcnt(18)
    s_nop 0
    v_mfma_f32_16x16x32_bf16 v[32:35], v[52:55], v[100:103], v[32:35]
    v_perm_b32 v30, v13, v13, s85
    v_and_b32 v48, v30, v4
    v_and_b32 v49, v30, v5
    v_and_b32 v50, v30, v6
    v_and_b32 v51, v30, v7
    s_waitcnt vmcnt(17)
    s_nop 0
    v_mfma_f32_16x16x32_bf16 v[32:35], v[48:51], v[104:107], v[32:35]
    v_perm_b32 v30, v13, v13, s86
    v_and_b32 v52, v30, v4
    v_and_b32 v53, v30, v5
    v_and_b32 v54, v30, v6
    v_and_b32 v55, v30, v7
    s_waitcnt vmcnt(16)
    s_nop 0
    v_mfma_f32_16x16x32_bf16 v[32:35], v[52:55], v[108:111], v[32:35]
    v_perm_b32 v30, v14, v14, s85
    v_and_b32 v48, v30, v4
    v_and_b32 v49, v30, v5
    v_and_b32 v50, v30, v6
    v_and_b32 v51, v30, v7
    s_waitcnt vmcnt(15)
    s_nop 0
    v_mfma_f32_16x16x32_bf16 v[32:35], v[48:51], v[112:115], v[32:35]
    v_perm_b32 v30, v14, v14, s86
    v_and_b32 v52, v30, v4
    v_and_b32 v53, v30, v5
    v_and_b32 v54, v30, v6
    v_and_b32 v55, v30, v7
    s_waitcnt vmcnt(14)
    s_nop 0
    v_mfma_f32_16x16x32_bf16 v[32:35], v[52:55], v[116:119], v[32:35]
    v_perm_b32 v30, v15, v15, s85
    v_and_b32 v48, v30, v4
    v_and_b32 v49, v30, v5
    v_and_b32 v50, v30, v6
    v_and_b32 v51, v30, v7
    s_waitcnt vmcnt(13)
    s_nop 0
    v_mfma_f32_16x16x32_bf16 v[32:35], v[48:51], v[120:123], v[32:35]
    v_perm_b32 v30, v15, v15, s86
    v_and_b32 v52, v30, v4
    v_and_b32 v53, v30, v5
    v_and_b32 v54, v30, v6
    v_and_b32 v55, v30, v7
    s_waitcnt vmcnt(12)
    s_nop 0
    v_mfma_f32_16x16x32_bf16 v[32:35], v[52:55], v[124:127], v[32:35]
    v_perm_b32 v30, v16, v16, s85
    v_and_b32 v48, v30, v4
    v_and_b32 v49, v30, v5
    v_and_b32 v50, v30, v6
    v_and_b32 v51, v30, v7
    s_waitcnt vmcnt(11)
    s_nop 0
    v_mfma_f32_16x16x32_bf16 v[32:35], v[48:51], v[128:131], v[32:35]
    v_perm_b32 v30, v16, v16, s86
    v_and_b32 v52, v30, v4
    v_and_b32 v53, v30, v5
    v_and_b32 v54, v30, v6
    v_and_b32 v55, v30, v7
    s_waitcnt vmcnt(10)
    s_nop 0
    v_mfma_f32_16x16x32_bf16 v[32:35], v[52:55], v[132:135], v[32:35]
    v_perm_b32 v30, v17, v17, s85
    v_and_b32 v48, v30, v4
    v_and_b32 v49, v30, v5
    v_and_b32 v50, v30, v6
    v_and_b32 v51, v30, v7
    s_waitcnt vmcnt(9)
    s_nop 0
    v_mfma_f32_16x16x32_bf16 v[32:35], v[48:51], v[136:139], v[32:35]
    v_perm_b32 v30, v17, v17, s86
    v_and_b32 v52, v30, v4
    v_and_b32 v53, v30, v5
    v_and_b32 v54, v30, v6
    v_and_b32 v55, v30, v7
    s_waitcnt vmcnt(8)
    s_nop 0
    v_mfma_f32_16x16x32_bf16 v[32:35], v[52:55], v[140:143], v[32:35]
    v_perm_b32 v30, v18, v18, s85
    v_and_b32 v48, v30, v4
    v_and_b32 v49, v30, v5
    v_and_b32 v50, v30, v6
    v_and_b32 v51, v30, v7
    s_waitcnt vmcnt(7)
    s_nop 0
    v_mfma_f32_16x16x32_bf16 v[32:35], v[48:51], v[144:147], v[32:35]
    v_perm_b32 v30, v18, v18, s86
    v_and_b32 v52, v30, v4
    v_and_b32 v53, v30, v5
    v_and_b32 v54, v30, v6
    v_and_b32 v55, v30, v7
    s_waitcnt vmcnt(6)
    s_nop 0
    v_mfma_f32_16x16x32_bf16 v[32:35], v[52:55], v[148:151], v[32:35]
    v_perm_b32 v30, v19, v19, s85
    v_and_b32 v48, v30, v4
    v_and_b32 v49, v30, v5
    v_and_b32 v50, v30, v6
    v_and_b32 v51, v30, v7
    s_waitcnt vmcnt(5)
    s_nop 0
    v_mfma_f32_16x16x32_bf16 v[32:35], v[48:51], v[152:155], v[32:35]
    v_perm_b32 v30, v19, v19, s86
    v_and_b32 v52, v30, v4
    v_and_b32 v53, v30, v5
    v_and_b32 v54, v30, v6
    v_and_b32 v55, v30, v7
    s_waitcnt vmcnt(4)
    s_nop 0
    v_mfma_f32_16x16x32_bf16 v[32:35], v[52:55], v[156:159], v[32:35]
    v_perm_b32 v30, v20, v20, s85
    v_and_b32 v48, v30, v4
    v_and_b32 v49, v30, v5
    v_and_b32 v50, v30, v6
    v_and_b32 v51, v30, v7
    s_waitcnt vmcnt(3)
    s_nop 0
    v_mfma_f32_16x16x32_bf16 v[32:35], v[48:51], v[160:163], v[32:35]
    v_perm_b32 v30, v20, v20, s86
    v_and_b32 v52, v30, v4
    v_and_b32 v53, v30, v5
    v_and_b32 v54, v30, v6
    v_and_b32 v55, v30, v7
    s_waitcnt vmcnt(2)
    s_nop 0
    v_mfma_f32_16x16x32_bf16 v[32:35], v[52:55], v[164:167], v[32:35]
    v_perm_b32 v30, v21, v21, s85
    v_and_b32 v48, v30, v4
    v_and_b32 v49, v30, v5
    v_and_b32 v50, v30, v6
    v_and_b32 v51, v30, v7
    s_waitcnt vmcnt(1)
    s_nop 0
    v_mfma_f32_16x16x32_bf16 v[32:35], v[48:51], v[168:171], v[32:35]
    v_perm_b32 v30, v21, v21, s86
    v_and_b32 v52, v30, v4
    v_and_b32 v53, v30, v5
    v_and_b32 v54, v30, v6
    v_and_b32 v55, v30, v7
    s_waitcnt vmcnt(0)
    s_nop 0
    v_mfma_f32_16x16x32_bf16 v[32:35], v[52:55], v[172:175], v[32:35]
    s_mul_i32 s85, s2, 3584
    v_and_b32 v2, 7, v0
    v_lshlrev_b32 v2, 4, v2
    v_and_b32 v3, 16, v0
    v_lshl_add_u32 v2, v3, 3, v2
    v_mov_b32 v60, 1536
    s_mov_b32 s92, 0
L_pf:
    ds_read_b32 v61, v60
    s_waitcnt lgkmcnt(0)
    v_cmp_gt_u32 vcc, 1, v61
    s_cbranch_vccz L_pfg
    s_sleep 1
    s_add_u32 s92, s92, 1
    s_cmp_lt_u32 s92, 8388608
    s_cbranch_scc1 L_pf
L_pfg:
    v_mov_b32 v36, v32
    v_mov_b32 v37, v33
    v_mov_b32 v38, v34
    v_mov_b32 v39, v35
    v_permlane32_swap_b32 v32, v36
    v_permlane32_swap_b32 v33, v37
    v_permlane32_swap_b32 v34, v38
    v_permlane32_swap_b32 v35, v39
    v_add_f32_dpp v32, v36, v32 row_ror:8 row_mask:0xf bank_mask:0xf
    v_add_f32_dpp v33, v37, v33 row_ror:8 row_mask:0xf bank_mask:0xf
    v_add_f32_dpp v34, v38, v34 row_ror:8 row_mask:0xf bank_mask:0xf
    v_add_f32_dpp v35, v39, v35 row_ror:8 row_mask:0xf bank_mask:0xf
    s_mov_b64 exec, 0x00ff00ff
    buffer_store_dwordx4 v[32:35], v2, s[60:63], s85 offen offset:3072 sc1
    s_mov_b64 exec, 1
    s_lshl_b32 s7, s5, 5
    v_mov_b32 v29, s7
    s_mov_b32 s92, 0
    s_waitcnt vmcnt(0)
L_pn:
    global_load_dword v9, v29, s[38:39] sc1
    s_waitcnt vmcnt(0)
    v_subrev_u32 v9, 1, v9
    v_and_b32 v9, 0x8000001f, v9
    v_cmp_ne_u32 vcc, 31, v9
    s_cbranch_vccz L_png
    s_sleep 4
    s_add_u32 s92, s92, 1
    s_cmp_lt_u32 s92, 1048576
    s_cbranch_scc1 L_pn
L_png:
    s_mov_b64 exec, -1
    s_mul_i32 s85, s5, 114688
    s_add_u32 s85, s85, 3072
    s_lshr_b32 s7, s6, 4
    s_mul_i32 s7, s7, 28672
    s_add_u32 s86, s85, 57344
    s_add_u32 s87, s85, 86016
    s_add_u32 s85, s85, s7
    v_lshrrev_b32 v28, 4, v0
    v_mul_u32_u24 v28, 7168, v28
    v_and_b32 v2, 15, v0
    v_lshl_add_u32 v28, v2, 4, v28
    v_and_b32 v3, 0x30, v0
    v_and_b32 v2, 7, v0
    v_lshl_add_u32 v2, v2, 1, v3
    v_bfe_u32 v3, v0, 3, 1
    v_add_lshl_u32 v2, v2, v3, 3
    s_mov_b32 s92, 0
L_pq:
    buffer_load_dwordx4 v[64:67], v28, s[60:63], s85 offen offset:0 sc1
    buffer_load_dwordx4 v[68:71], v28, s[60:63], s85 offen offset:3584 sc1
    buffer_load_dwordx4 v[72:75], v28, s[60:63], s86 offen offset:0 sc1
    buffer_load_dwordx4 v[76:79], v28, s[60:63], s86 offen offset:3584 sc1
    buffer_load_dwordx4 v[80:83], v28, s[60:63], s87 offen offset:0 sc1
    buffer_load_dwordx4 v[84:87], v28, s[60:63], s87 offen offset:3584 sc1
    s_waitcnt vmcnt(0)
    v_max_u32 v8, v64, v65
    v_max3_u32 v8, v8, v66, v67
    v_max3_u32 v8, v8, v68, v69
    v_max3_u32 v8, v8, v70, v71
    v_max3_u32 v8, v8, v72, v73
    v_max3_u32 v8, v8, v74, v75
    v_max3_u32 v8, v8, v76, v77
    v_max3_u32 v8, v8, v78, v79
    v_max3_u32 v8, v8, v80, v81
    v_max3_u32 v8, v8, v82, v83
    v_max3_u32 v8, v8, v84, v85
    v_max3_u32 v8, v8, v86, v87
    v_cmp_eq_u32 vcc, -1, v8
    s_cbranch_vccz L_pqg
    s_add_u32 s92, s92, 1
    s_cmp_lt_u32 s92, 1048576
    s_cbranch_scc1 L_pq
L_pqg:
    v_add_f32 v64, v64, v68
    v_add_f32 v65, v65, v69
    v_add_f32 v66, v66, v70
    v_add_f32 v67, v67, v71
    v_cvt_pk_bf16_f32 v64, v64, v65
    v_cvt_pk_bf16_f32 v65, v66, v67
    ds_write_b64 v2, v[64:65] offset:0
    v_add_f32 v72, v72, v76
    v_add_f32 v73, v73, v77
    v_add_f32 v74, v74, v78
    v_add_f32 v75, v75, v79
    v_cvt_pk_bf16_f32 v72, v72, v73
    v_cvt_pk_bf16_f32 v73, v74, v75
    ds_write_b64 v2, v[72:73] offset:512
    v_add_f32 v80, v80, v84
    v_add_f32 v81, v81, v85
    v_add_f32 v82, v82, v86
    v_add_f32 v83, v83, v87
    v_cvt_pk_bf16_f32 v80, v80, v81
    v_cvt_pk_bf16_f32 v81, v82, v83
    ds_write_b64 v2, v[80:81] offset:1024
    s_waitcnt lgkmcnt(0)
    s_setprio 0
    s_branch L_setup
    .p2align 6
L_svcB:
    s_setprio 3
    s_mul_i32 s87, s2, 3584
    s_mul_i32 s88, s2, 1792
    s_add_u32 s88, s88, 917504
    v_mov_b32 v24, -1
    v_mov_b32 v25, -1
    v_mov_b32 v26, -1
    v_mov_b32 v27, -1
    v_lshlrev_b32 v28, 4, v0
    s_waitcnt lgkmcnt(0)
    s_mov_b32 s60, s40
    s_mov_b32 s61, s41
    buffer_store_dwordx4 v[24:27], v28, s[60:63], s87 offen sc1
    buffer_store_dwordx4 v[24:27], v28, s[60:63], s87 offen offset:1024 sc1
    buffer_store_dwordx4 v[24:27], v28, s[60:63], s87 offen offset:2048 sc1
    buffer_store_dwordx4 v[24:27], v28, s[60:63], s88 offen sc1
    s_mov_b32 exec_hi, 0xffff
    buffer_store_dwordx4 v[24:27], v28, s[60:63], s88 offen offset:1024 sc1
    s_cmp_lt_u32 s6, 4
    s_cselect_b32 exec_lo, -1, 0xffffff
    s_mov_b32 exec_hi, 0
    buffer_store_dwordx4 v[24:27], v28, s[60:63], s87 offen offset:3072 sc1
    s_mov_b64 exec, -1
    s_lshl_b32 s7, s5, 5
    s_add_u32 s90, s38, s7
    s_addc_u32 s91, s39, 0
    s_mov_b32 s93, 1
    v_mov_b32 v2, 1536
    v_mov_b32 v3, 1
    s_waitcnt vmcnt(0)
    s_atomic_add s93, s[90:91], 0
    s_barrier
    ds_write_b32 v2, v3
    s_setprio 0
    s_branch L_setup
.fill 256, 4, 0xbf810000
.section .rodata,"a"
.p2align 6
.amdhsa_kernel concat_heads__sliding_block_cached__mha_block_cached__decode_kernel
  .amdhsa_next_free_vgpr 256
  .amdhsa_next_free_sgpr 102
  .amdhsa_accum_offset 256
  .amdhsa_group_segment_fixed_size 0
  .amdhsa_kernarg_size 104
  .amdhsa_user_sgpr_count 2
  .amdhsa_user_sgpr_kernarg_segment_ptr 1
  .amdhsa_system_sgpr_workgroup_id_x 1
.end_amdhsa_kernel
```
